```python
import torch

def _softmax(x, axis=-1):
    return torch.softmax(x, dim=axis)
def _gelu(x):
    return torch.nn.functional.gelu(x, approximate="tanh")
def _silu(x):
    return torch.nn.functional.silu(x)
def _sigmoid(x):
    return torch.sigmoid(x)
def _layernorm(x, axis=-1, eps=1e-5):
    m = x.mean(dim=axis, keepdim=True)
    v = x.var(dim=axis, keepdim=True, unbiased=False)
    return (x - m) / torch.sqrt(v + eps)
def _scatter_add(tgt, idx, src, axis=0):
    return tgt.clone().index_add_(axis, idx, src)
def _segment_sum(src, seg, n):
    out = torch.zeros((n,) + src.shape[1:], dtype=src.dtype)
    return out.index_add_(0, seg, src)
def _pad(x, pw):
    flat = tuple(v for pair in reversed(pw) for v in pair)
    return torch.nn.functional.pad(x, flat)

kernel_name = 'sequential_preLN__gqa_block_cached__glu_gated_reglu__decode'

def setup_inputs():

    _w = (lambda a: (lambda t: t.to(torch.bfloat16) if t.is_floating_point() else t)(torch.as_tensor(a)))
    def _A_setup():
        B, Sq, D = 2, 1, 512
        Hq, Hkv, Sk, Dh = 32, 32, 8192, 128
        assert Hq % Hkv == 0, (Hq, Hkv)
        return {
            "x": _w((lambda *s: torch.randn(*s, dtype=torch.bfloat16) * 0.05)(B, Sq, D)),
            "k_cache": _w((lambda *s: torch.randn(*s, dtype=torch.bfloat16) * 1.6)(B, Hkv, Sk, Dh)),
            "v_cache": _w((lambda *s: torch.randn(*s, dtype=torch.bfloat16) * 0.8)(B, Hkv, Sk, Dh)),
            "wq": _w((lambda *s: torch.randn(*s, dtype=torch.bfloat16) * 1.6)(D, Hq * Dh) * (D ** -0.5)),
            "wo": _w((lambda *s: torch.randn(*s, dtype=torch.bfloat16) * 0.8)(Hq * Dh, D) * ((Hq * Dh) ** -0.5)),
        }
    _A_in = _A_setup()

    def _B_setup():
        B, S, D, F = 2, 1, 512, 1376
        return {
            "x": _w((lambda *s: torch.randn(*s, dtype=torch.bfloat16) * 0.05)(B, S, D)),
            "W_gate": _w((lambda *s: torch.randn(*s, dtype=torch.bfloat16) * 0.4)(D, F) * (2.0 / D) ** 0.5),
            "W_up": _w((lambda *s: torch.randn(*s, dtype=torch.bfloat16) * 0.4)(D, F) * (2.0 / D) ** 0.5),
            "W_down": _w((lambda *s: torch.randn(*s, dtype=torch.bfloat16) * 0.4)(F, D) * (1.0 / F) ** 0.5),
        }
    _B_in = _B_setup()

    return {
        "A_x": _A_in["x"],
        "A_k_cache": _A_in["k_cache"],
        "A_v_cache": _A_in["v_cache"],
        "A_wq": _A_in["wq"],
        "A_wo": _A_in["wo"],
        "B_x": _B_in["x"],
        "B_W_gate": _B_in["W_gate"],
        "B_W_up": _B_in["W_up"],
        "B_W_down": _B_in["W_down"],
    }

def reference(A_x, A_k_cache, A_v_cache, A_wq, A_wo, B_x, B_W_gate, B_W_up, B_W_down):
    def _A_ref(x, k_cache, v_cache, wq, wo):
        B, Sq, D = x.shape
        Hq, Dh = 32, 128
        Hkv = k_cache.shape[1]
        rep = Hq // Hkv
        q = (lambda x, *d: x.permute(*d))((x @ wq).reshape(B, Sq, Hq, Dh), 0, 2, 1, 3)
        k = (lambda x, n, axis: torch.repeat_interleave(x, n, dim=axis))(k_cache, rep, axis=1)
        v = (lambda x, n, axis: torch.repeat_interleave(x, n, dim=axis))(v_cache, rep, axis=1)
        scores = torch.einsum("bhqd,bhkd->bhqk", q, k) * (Dh ** -0.5)
        p = _softmax(scores, axis=-1)
        o = torch.einsum("bhqk,bhkd->bhqd", p, v)
        return (lambda x, *d: x.permute(*d))(o, 0, 2, 1, 3).reshape(B, Sq, Hq * Dh) @ wo

    def _B_ref(x, W_gate, W_up, W_down):
        gate = torch.einsum("bsd,df->bsf", x, W_gate)
        up = torch.einsum("bsd,df->bsf", x, W_up)
        gate = gate * (lambda x, dt: x.to(dt))(gate > 0, gate.dtype)
        h = gate * up
        return torch.einsum("bsf,fd->bsd", h, W_down)

    x = A_x
    h = x + _A_ref(_layernorm(x, axis=-1), A_k_cache, A_v_cache, A_wq, A_wo)
    h2 = h + _B_ref(_layernorm(h, axis=-1), B_W_gate, B_W_up, B_W_down)
    return h2
```

```asm
; @launch grid=(256,1,1) block=(512,1,1) lds=32768
.amdgcn_target "amdgcn-amd-amdhsa--gfx950"
.text
.p2align 12
.globl sequential_preLN__gqa_block_cached__glu_gated_reglu__decode_kernel
.p2align 8
.type sequential_preLN__gqa_block_cached__glu_gated_reglu__decode_kernel,@function
sequential_preLN__gqa_block_cached__glu_gated_reglu__decode_kernel:
    s_cmp_ge_u32 s2, 256
    s_cbranch_scc1 L_end
    s_load_dwordx16 s[16:31], s[0:1], 0
    s_load_dwordx8 s[32:39], s[0:1], 64
    v_lshrrev_b32 v4, 6, v0
    v_and_b32 v3, 63, v0
    v_readfirstlane_b32 s3, v4
    v_lshlrev_b32 v1, 4, v3
    v_add_u32 v55, 0x10000, v1
    s_lshr_b32 s57, s2, 3
    s_and_b32 s58, s2, 7
    s_cmp_lg_u32 s3, 0
    s_cbranch_scc1 L_head_other
    v_lshlrev_b32 v224, 5, v3
    v_lshrrev_b32 v225, 5, v3
    v_and_b32 v226, 31, v3
    v_lshlrev_b32 v225, 10, v225
    v_lshl_add_u32 v225, v226, 2, v225
    s_lshl_b32 s4, s58, 7
    v_add_u32 v225, s4, v225
    v_lshrrev_b32 v227, 4, v3
    v_lshlrev_b32 v228, 17, v227
    v_and_b32 v229, 15, v3
    v_lshl_add_u32 v228, v229, 4, v228
    s_lshl_b32 s4, s58, 19
    s_lshl_b32 s5, s57, 8
    s_add_u32 s4, s4, s5
    s_mov_b32 s50, 0x400000
    s_mov_b32 s51, 0x20000
    s_waitcnt lgkmcnt(0)
    global_load_dwordx4 v[144:147], v224, s[16:17]
    global_load_dwordx4 v[148:151], v224, s[16:17] offset:16
    global_load_dword v152, v225, s[16:17]
    s_mov_b32 s48, s22
    s_and_b32 s49, s23, 0xffff
    buffer_load_dwordx4 v[64:67], v228, s[48:51], s4 offen nt
    s_add_u32 s4, s4, 8192
    buffer_load_dwordx4 v[68:71], v228, s[48:51], s4 offen nt
    s_add_u32 s4, s4, 8192
    buffer_load_dwordx4 v[72:75], v228, s[48:51], s4 offen nt
    s_add_u32 s4, s4, 8192
    buffer_load_dwordx4 v[76:79], v228, s[48:51], s4 offen nt
    s_add_u32 s4, s4, 8192
    buffer_load_dwordx4 v[80:83], v228, s[48:51], s4 offen nt
    s_add_u32 s4, s4, 8192
    buffer_load_dwordx4 v[84:87], v228, s[48:51], s4 offen nt
    s_add_u32 s4, s4, 8192
    buffer_load_dwordx4 v[88:91], v228, s[48:51], s4 offen nt
    s_add_u32 s4, s4, 8192
    buffer_load_dwordx4 v[92:95], v228, s[48:51], s4 offen nt
    s_add_u32 s4, s4, 8192
    buffer_load_dwordx4 v[96:99], v228, s[48:51], s4 offen nt
    s_add_u32 s4, s4, 8192
    buffer_load_dwordx4 v[100:103], v228, s[48:51], s4 offen nt
    s_add_u32 s4, s4, 8192
    buffer_load_dwordx4 v[104:107], v228, s[48:51], s4 offen nt
    s_add_u32 s4, s4, 8192
    buffer_load_dwordx4 v[108:111], v228, s[48:51], s4 offen nt
    s_add_u32 s4, s4, 8192
    buffer_load_dwordx4 v[112:115], v228, s[48:51], s4 offen nt
    s_add_u32 s4, s4, 8192
    buffer_load_dwordx4 v[116:119], v228, s[48:51], s4 offen nt
    s_add_u32 s4, s4, 8192
    buffer_load_dwordx4 v[120:123], v228, s[48:51], s4 offen nt
    s_add_u32 s4, s4, 8192
    buffer_load_dwordx4 v[124:127], v228, s[48:51], s4 offen nt
    s_barrier
    s_branch L_w0_post
L_head_other:
    s_cmp_eq_u32 s3, 1
    s_cbranch_scc1 L_tch0
    s_cmp_eq_u32 s3, 2
    s_cbranch_scc1 L_tch1
    s_cmp_eq_u32 s3, 3
    s_cbranch_scc1 L_tch2
    s_cmp_eq_u32 s3, 4
    s_cbranch_scc1 L_tch3
    s_cmp_eq_u32 s3, 5
    s_cbranch_scc1 L_tch4
    s_cmp_eq_u32 s3, 6
    s_cbranch_scc1 L_tch5
    s_cmp_eq_u32 s3, 7
    s_cbranch_scc1 L_touch0_ret
L_touch0_ret:
    s_cmp_eq_u32 s58, 0
    s_cselect_b32 s79, s57, 255
    s_cmp_lt_u32 s57, 22
    s_mov_b32 s6, 0x6e0058
    s_cselect_b32 s6, 0x720048, s6
    s_and_b32 s5, s6, 0xffff
    s_lshr_b32 s6, s6, 16
    s_mul_i32 s7, s58, s6
    s_add_u32 s7, s7, s5
    s_sub_u32 s7, s7, s6
    s_cmp_eq_u32 s58, 0
    s_cselect_b32 s98, 0, s7
    s_cselect_b32 s54, s5, s6
    s_mul_i32 s5, s57, 74
    s_and_b32 s53, s5, 1023
    s_lshl_b32 s10, s57, 9
    s_and_b32 s5, s3, 3
    s_lshl_b32 s5, s5, 7
    s_add_u32 s10, s10, s5
    s_add_u32 s10, s10, 0xc0000
    s_lshl_b32 s52, s57, 21
    v_mov_b32 v62, 0
    v_mov_b32 v63, 4
    v_mov_b32 v2, 0
    s_waitcnt lgkmcnt(0)
    s_load_dword s96, s[38:39], 0x0
    s_mov_b32 s40, s18
    s_and_b32 s41, s19, 0xffff
    s_mov_b32 s42, 0x8000000
    s_mov_b32 s43, 0x20000
    s_mov_b32 s44, s20
    s_and_b32 s45, s21, 0xffff
    s_mov_b32 s46, 0x8000000
    s_mov_b32 s47, 0x20000
    s_add_u32 s70, s38, 0x10000
    s_addc_u32 s71, s39, 0
    s_add_u32 s72, s38, 0x54000
    s_addc_u32 s73, s39, 0
    s_add_u32 s74, s38, 0x60000
    s_addc_u32 s75, s39, 0
    s_add_u32 s12, s38, 0x80000
    s_addc_u32 s13, s39, 0
    s_add_u32 s100, s38, s10
    s_addc_u32 s101, s39, 0
    s_barrier
    s_cmp_lg_u32 s79, 255
    s_cbranch_scc1 L_ft_role1
    s_lshl_b32 s4, s3, 1
    s_add_u32 s4, s4, s98
    s_add_u32 s5, s4, s53
    s_and_b32 s5, s5, 1023
    s_and_b32 s11, s5, 15
    s_mul_i32 s11, s11, 17
    s_bfe_u32 s11, s11, 0x40001
    s_andn2_b32 s5, s5, 15
    s_or_b32 s5, s5, s11
    s_andn2_b32 s11, s5, 63
    s_add_u32 s5, s5, s11
    s_lshl_b32 s5, s5, 10
    s_add_u32 s55, s5, s52
    s_xor_b32 s56, s55, 0x4000800
    buffer_load_dwordx4 v[128:131], v1, s[40:43], s55 offen nt
    buffer_load_dwordx4 v[132:135], v55, s[40:43], s55 offen nt
    buffer_load_dwordx4 v[136:139], v1, s[40:43], s56 offen nt
    buffer_load_dwordx4 v[140:143], v55, s[40:43], s56 offen nt
    buffer_load_dwordx4 v[160:163], v1, s[44:47], s55 offen nt
    buffer_load_dwordx4 v[164:167], v55, s[44:47], s55 offen nt
    buffer_load_dwordx4 v[168:171], v1, s[44:47], s56 offen nt
    buffer_load_dwordx4 v[172:175], v55, s[44:47], s56 offen nt
    s_add_u32 s55, s55, 0x2000
    s_xor_b32 s56, s55, 0x4000800
    buffer_load_dwordx4 v[144:147], v1, s[40:43], s55 offen nt
    buffer_load_dwordx4 v[148:151], v55, s[40:43], s55 offen nt
    buffer_load_dwordx4 v[152:155], v1, s[40:43], s56 offen nt
    buffer_load_dwordx4 v[156:159], v55, s[40:43], s56 offen nt
    buffer_load_dwordx4 v[176:179], v1, s[44:47], s55 offen nt
    buffer_load_dwordx4 v[180:183], v55, s[44:47], s55 offen nt
    buffer_load_dwordx4 v[184:187], v1, s[44:47], s56 offen nt
    buffer_load_dwordx4 v[188:191], v55, s[44:47], s56 offen nt
    s_lshl_b32 s4, s3, 1
    s_add_u32 s4, s4, s98
    s_add_u32 s4, s4, 32
    s_add_u32 s5, s4, s53
    s_and_b32 s5, s5, 1023
    s_and_b32 s11, s5, 15
    s_mul_i32 s11, s11, 17
    s_bfe_u32 s11, s11, 0x40001
    s_andn2_b32 s5, s5, 15
    s_or_b32 s5, s5, s11
    s_andn2_b32 s11, s5, 63
    s_add_u32 s5, s5, s11
    s_lshl_b32 s5, s5, 10
    s_add_u32 s55, s5, s52
    s_xor_b32 s56, s55, 0x4000800
    buffer_load_dwordx4 v[64:67], v1, s[40:43], s55 offen nt
    buffer_load_dwordx4 v[68:71], v55, s[40:43], s55 offen nt
    buffer_load_dwordx4 v[72:75], v1, s[40:43], s56 offen nt
    buffer_load_dwordx4 v[76:79], v55, s[40:43], s56 offen nt
    buffer_load_dwordx4 v[96:99], v1, s[44:47], s55 offen nt
    buffer_load_dwordx4 v[100:103], v55, s[44:47], s55 offen nt
    buffer_load_dwordx4 v[104:107], v1, s[44:47], s56 offen nt
    buffer_load_dwordx4 v[108:111], v55, s[44:47], s56 offen nt
    s_add_u32 s55, s55, 0x2000
    s_xor_b32 s56, s55, 0x4000800
    buffer_load_dwordx4 v[80:83], v1, s[40:43], s55 offen nt
    buffer_load_dwordx4 v[84:87], v55, s[40:43], s55 offen nt
    buffer_load_dwordx4 v[88:91], v1, s[40:43], s56 offen nt
    buffer_load_dwordx4 v[92:95], v55, s[40:43], s56 offen nt
    buffer_load_dwordx4 v[112:115], v1, s[44:47], s55 offen nt
    buffer_load_dwordx4 v[116:119], v55, s[44:47], s55 offen nt
    buffer_load_dwordx4 v[120:123], v1, s[44:47], s56 offen nt
    buffer_load_dwordx4 v[124:127], v55, s[44:47], s56 offen nt
    s_lshl_b32 s4, s3, 1
    s_add_u32 s4, s4, s98
    s_add_u32 s4, s4, 16
    s_add_u32 s5, s4, s53
    s_and_b32 s5, s5, 1023
    s_and_b32 s11, s5, 15
    s_mul_i32 s11, s11, 17
    s_bfe_u32 s11, s11, 0x40001
    s_andn2_b32 s5, s5, 15
    s_or_b32 s5, s5, s11
    s_andn2_b32 s11, s5, 63
    s_add_u32 s5, s5, s11
    s_lshl_b32 s5, s5, 10
    s_add_u32 s55, s5, s52
    s_xor_b32 s56, s55, 0x4000800
    buffer_load_dwordx4 v[192:195], v1, s[40:43], s55 offen nt
    buffer_load_dwordx4 v[196:199], v55, s[40:43], s55 offen nt
    buffer_load_dwordx4 v[200:203], v1, s[40:43], s56 offen nt
    buffer_load_dwordx4 v[204:207], v55, s[40:43], s56 offen nt
    buffer_load_dwordx4 v[224:227], v1, s[44:47], s55 offen nt
    buffer_load_dwordx4 v[228:231], v55, s[44:47], s55 offen nt
    buffer_load_dwordx4 v[232:235], v1, s[44:47], s56 offen nt
    buffer_load_dwordx4 v[236:239], v55, s[44:47], s56 offen nt
    s_add_u32 s55, s55, 0x2000
    s_xor_b32 s56, s55, 0x4000800
    buffer_load_dwordx4 v[208:211], v1, s[40:43], s55 offen nt
    buffer_load_dwordx4 v[212:215], v55, s[40:43], s55 offen nt
    buffer_load_dwordx4 v[216:219], v1, s[40:43], s56 offen nt
    buffer_load_dwordx4 v[220:223], v55, s[40:43], s56 offen nt
    buffer_load_dwordx4 v[240:243], v1, s[44:47], s55 offen nt
    buffer_load_dwordx4 v[244:247], v55, s[44:47], s55 offen nt
    buffer_load_dwordx4 v[248:251], v1, s[44:47], s56 offen nt
    buffer_load_dwordx4 v[252:255], v55, s[44:47], s56 offen nt
    s_branch L_ft_done1
L_ft_role1:
    v_mov_b32 v132, 0
    v_mov_b32 v133, 0
    v_mov_b32 v134, 0
    v_mov_b32 v135, 0
    v_mov_b32 v136, 0
    v_mov_b32 v137, 0
    v_mov_b32 v138, 0
    v_mov_b32 v139, 0
    v_mov_b32 v140, 0
    v_mov_b32 v141, 0
    v_mov_b32 v142, 0
    s_cmp_ge_u32 s3, 4
    s_cbranch_scc1 L_ft_w1
    s_lshl_b32 s4, s3, 1
    s_add_u32 s4, s4, s98
    s_add_u32 s5, s4, s53
    s_and_b32 s5, s5, 1023
    s_and_b32 s11, s5, 15
    s_mul_i32 s11, s11, 17
    s_bfe_u32 s11, s11, 0x40001
    s_andn2_b32 s5, s5, 15
    s_or_b32 s5, s5, s11
    s_andn2_b32 s11, s5, 63
    s_add_u32 s5, s5, s11
    s_lshl_b32 s5, s5, 10
    s_add_u32 s55, s5, s52
    s_xor_b32 s56, s55, 0x4000800
    buffer_load_dwordx4 v[128:131], v1, s[40:43], s55 offen nt
    buffer_load_dwordx4 v[132:135], v55, s[40:43], s55 offen nt
    buffer_load_dwordx4 v[136:139], v1, s[40:43], s56 offen nt
    buffer_load_dwordx4 v[140:143], v55, s[40:43], s56 offen nt
    buffer_load_dwordx4 v[160:163], v1, s[44:47], s55 offen nt
    buffer_load_dwordx4 v[164:167], v55, s[44:47], s55 offen nt
    buffer_load_dwordx4 v[168:171], v1, s[44:47], s56 offen nt
    buffer_load_dwordx4 v[172:175], v55, s[44:47], s56 offen nt
    s_add_u32 s55, s55, 0x2000
    s_xor_b32 s56, s55, 0x4000800
    buffer_load_dwordx4 v[144:147], v1, s[40:43], s55 offen nt
    buffer_load_dwordx4 v[148:151], v55, s[40:43], s55 offen nt
    buffer_load_dwordx4 v[152:155], v1, s[40:43], s56 offen nt
    buffer_load_dwordx4 v[156:159], v55, s[40:43], s56 offen nt
    buffer_load_dwordx4 v[176:179], v1, s[44:47], s55 offen nt
    buffer_load_dwordx4 v[180:183], v55, s[44:47], s55 offen nt
    buffer_load_dwordx4 v[184:187], v1, s[44:47], s56 offen nt
    buffer_load_dwordx4 v[188:191], v55, s[44:47], s56 offen nt
L_ft_w1:
    s_mov_b32 s48, s24
    s_and_b32 s49, s25, 0xffff
    s_mov_b32 s50, 0x400000
    s_mov_b32 s51, 0x20000
    v_bfe_u32 v42, v3, 3, 1
    v_lshlrev_b32 v42, 5, v42
    v_lshrrev_b32 v43, 4, v3
    v_lshl_add_u32 v42, v43, 3, v42
    v_mul_u32_u24 v42, 1024, v42
    v_and_b32 v43, 7, v3
    v_lshl_add_u32 v46, v43, 4, v42
    s_lshr_b32 s4, s79, 3
    s_lshl_b32 s4, s4, 3
    s_add_u32 s4, s4, s3
    s_lshl_b32 s4, s4, 17
    s_and_b32 s5, s79, 7
    s_lshl_b32 s5, s5, 7
    s_add_u32 s4, s4, s5
    buffer_load_dwordx4 v[64:67], v46, s[48:51], s4 offen nt
    s_add_u32 s4, s4, 1024
    buffer_load_dwordx4 v[68:71], v46, s[48:51], s4 offen nt
    s_add_u32 s4, s4, 1024
    buffer_load_dwordx4 v[72:75], v46, s[48:51], s4 offen nt
    s_add_u32 s4, s4, 1024
    buffer_load_dwordx4 v[76:79], v46, s[48:51], s4 offen nt
    s_add_u32 s4, s4, 1024
    buffer_load_dwordx4 v[80:83], v46, s[48:51], s4 offen nt
    s_add_u32 s4, s4, 1024
    buffer_load_dwordx4 v[84:87], v46, s[48:51], s4 offen nt
    s_add_u32 s4, s4, 1024
    buffer_load_dwordx4 v[88:91], v46, s[48:51], s4 offen nt
    s_add_u32 s4, s4, 1024
    buffer_load_dwordx4 v[92:95], v46, s[48:51], s4 offen nt
    s_add_u32 s4, s4, 58368
    buffer_load_dwordx4 v[96:99], v46, s[48:51], s4 offen nt
    s_add_u32 s4, s4, 1024
    buffer_load_dwordx4 v[100:103], v46, s[48:51], s4 offen nt
    s_add_u32 s4, s4, 1024
    buffer_load_dwordx4 v[104:107], v46, s[48:51], s4 offen nt
    s_add_u32 s4, s4, 1024
    buffer_load_dwordx4 v[108:111], v46, s[48:51], s4 offen nt
    s_add_u32 s4, s4, 1024
    buffer_load_dwordx4 v[112:115], v46, s[48:51], s4 offen nt
    s_add_u32 s4, s4, 1024
    buffer_load_dwordx4 v[116:119], v46, s[48:51], s4 offen nt
    s_add_u32 s4, s4, 1024
    buffer_load_dwordx4 v[120:123], v46, s[48:51], s4 offen nt
    s_add_u32 s4, s4, 1024
    buffer_load_dwordx4 v[124:127], v46, s[48:51], s4 offen nt
    s_cmp_ge_u32 s79, 22
    s_cbranch_scc1 L_pf_done1
    s_cmp_lt_u32 s3, 4
    s_cselect_b32 s6, s28, s30
    s_cselect_b32 s7, s29, s31
    s_mov_b32 s48, s6
    s_and_b32 s49, s7, 0xffff
    s_mov_b32 s50, 0x158000
    s_mov_b32 s51, 0x20000
    v_bfe_u32 v42, v3, 3, 1
    v_lshlrev_b32 v42, 5, v42
    v_lshrrev_b32 v43, 4, v3
    v_lshl_add_u32 v42, v43, 3, v42
    v_mul_u32_u24 v42, 2752, v42
    v_and_b32 v43, 7, v3
    v_lshl_add_u32 v46, v43, 4, v42
    s_and_b32 s4, s3, 3
    s_mul_i32 s4, s4, 352256
    s_lshl_b32 s5, s79, 7
    s_add_u32 s4, s4, s5
    buffer_load_dwordx4 v[192:195], v46, s[48:51], s4 offen nt
    s_add_u32 s4, s4, 2752
    buffer_load_dwordx4 v[196:199], v46, s[48:51], s4 offen nt
    s_add_u32 s4, s4, 2752
    buffer_load_dwordx4 v[200:203], v46, s[48:51], s4 offen nt
    s_add_u32 s4, s4, 2752
    buffer_load_dwordx4 v[204:207], v46, s[48:51], s4 offen nt
    s_add_u32 s4, s4, 2752
    buffer_load_dwordx4 v[208:211], v46, s[48:51], s4 offen nt
    s_add_u32 s4, s4, 2752
    buffer_load_dwordx4 v[212:215], v46, s[48:51], s4 offen nt
    s_add_u32 s4, s4, 2752
    buffer_load_dwordx4 v[216:219], v46, s[48:51], s4 offen nt
    s_add_u32 s4, s4, 2752
    buffer_load_dwordx4 v[220:223], v46, s[48:51], s4 offen nt
    s_add_u32 s4, s4, 156864
    buffer_load_dwordx4 v[224:227], v46, s[48:51], s4 offen nt
    s_add_u32 s4, s4, 2752
    buffer_load_dwordx4 v[228:231], v46, s[48:51], s4 offen nt
    s_add_u32 s4, s4, 2752
    buffer_load_dwordx4 v[232:235], v46, s[48:51], s4 offen nt
    s_add_u32 s4, s4, 2752
    buffer_load_dwordx4 v[236:239], v46, s[48:51], s4 offen nt
    s_add_u32 s4, s4, 2752
    buffer_load_dwordx4 v[240:243], v46, s[48:51], s4 offen nt
    s_add_u32 s4, s4, 2752
    buffer_load_dwordx4 v[244:247], v46, s[48:51], s4 offen nt
    s_add_u32 s4, s4, 2752
    buffer_load_dwordx4 v[248:251], v46, s[48:51], s4 offen nt
    s_add_u32 s4, s4, 2752
    buffer_load_dwordx4 v[252:255], v46, s[48:51], s4 offen nt
    s_cmp_lt_u32 s3, 4
    s_cbranch_scc1 L_pf_done1
    s_mov_b32 s48, s32
    s_and_b32 s49, s33, 0xffff
    s_mov_b32 s50, 0x158000
    s_mov_b32 s51, 0x20000
    v_lshrrev_b32 v42, 4, v3
    v_lshlrev_b32 v42, 13, v42
    v_and_b32 v43, 15, v3
    v_lshl_add_u32 v46, v43, 4, v42
    s_lshl_b32 s4, s79, 16
    s_and_b32 s5, s3, 3
    s_lshl_b32 s5, s5, 8
    s_add_u32 s4, s4, s5
    buffer_load_dwordx4 v[128:131], v46, s[48:51], s4 offen nt
    s_add_u32 s4, s4, 1024
    buffer_load_dwordx4 v[132:135], v46, s[48:51], s4 offen nt
    s_add_u32 s4, s4, 1024
    buffer_load_dwordx4 v[136:139], v46, s[48:51], s4 offen nt
    s_add_u32 s4, s4, 1024
    buffer_load_dwordx4 v[140:143], v46, s[48:51], s4 offen nt
    s_add_u32 s4, s4, 1024
    buffer_load_dwordx4 v[144:147], v46, s[48:51], s4 offen nt
    s_add_u32 s4, s4, 1024
    buffer_load_dwordx4 v[148:151], v46, s[48:51], s4 offen nt
    s_add_u32 s4, s4, 1024
    buffer_load_dwordx4 v[152:155], v46, s[48:51], s4 offen nt
    s_add_u32 s4, s4, 1024
    buffer_load_dwordx4 v[156:159], v46, s[48:51], s4 offen nt
    s_add_u32 s4, s4, 25600
    buffer_load_dwordx4 v[160:163], v46, s[48:51], s4 offen nt
    s_add_u32 s4, s4, 1024
    buffer_load_dwordx4 v[164:167], v46, s[48:51], s4 offen nt
    s_add_u32 s4, s4, 1024
    buffer_load_dwordx4 v[168:171], v46, s[48:51], s4 offen nt
    s_add_u32 s4, s4, 1024
    buffer_load_dwordx4 v[172:175], v46, s[48:51], s4 offen nt
    s_add_u32 s4, s4, 1024
    buffer_load_dwordx4 v[176:179], v46, s[48:51], s4 offen nt
    s_add_u32 s4, s4, 1024
    buffer_load_dwordx4 v[180:183], v46, s[48:51], s4 offen nt
    s_add_u32 s4, s4, 1024
    buffer_load_dwordx4 v[184:187], v46, s[48:51], s4 offen nt
    s_add_u32 s4, s4, 1024
    buffer_load_dwordx4 v[188:191], v46, s[48:51], s4 offen nt
L_pf_done1:
L_ft_done1:
    s_mov_b32 s60, 0x05040100
    s_mov_b32 s61, 0x07060302
    s_mov_b32 s62, 0x07060500
    s_mov_b32 s63, 0x07060501
    s_mov_b32 s64, 0x07060502
    s_mov_b32 s65, 0x07060503
    s_mov_b32 s66, 0x0c0c0400
    s_mov_b32 s67, 0x04000c0c
    s_mov_b32 s68, 0x3fb8aa3b
    s_mov_b32 s69, 0x3db504f3
    s_waitcnt lgkmcnt(0)
    s_and_b32 s4, s96, 0xff
    s_bfe_u32 s5, s96, 0x80008
    s_or_b32 s5, s5, 1
    s_xor_b32 s5, s4, s5
    s_lshl_b32 s5, s5, 8
    s_or_b32 s4, s4, s5
    s_and_b32 s5, s96, 0xffff00
    s_lshl_b32 s5, s5, 8
    s_or_b32 s59, s4, s5
    v_mov_b32 v58, s59
    s_cmp_lg_u32 s3, 4
    s_cbranch_scc1 L_nocensus
    s_cmp_eq_u32 s79, 255
    s_cbranch_scc1 L_nocensus
    s_getreg_b32 s4, hwreg(HW_REG_XCC_ID)
    s_and_b32 s4, s4, 15
    s_lshl_b32 s4, s4, 8
    v_mov_b32 v50, s4
    v_mov_b32 v51, s4
    v_mov_b32 v52, s4
    v_mov_b32 v53, s4
    v_perm_b32 v50, v50, v58, s62
    v_perm_b32 v51, v51, v58, s63
    v_perm_b32 v52, v52, v58, s64
    v_perm_b32 v53, v53, v58, s65
    s_lshl_b32 s4, s79, 4
    s_add_u32 s4, s4, 0x1000
    v_mov_b32 v54, s4
    s_mov_b64 exec, 1
    global_store_dwordx4 v54, v[50:53], s[38:39] sc1
    s_mov_b64 exec, -1
L_nocensus:
    s_cmp_eq_u32 s3, 1
    s_cbranch_scc1 L_tch10
    s_cmp_eq_u32 s3, 2
    s_cbranch_scc1 L_tch11
    s_cmp_eq_u32 s3, 3
    s_cbranch_scc1 L_tch12
    s_cmp_eq_u32 s3, 4
    s_cbranch_scc1 L_tch13
    s_cmp_eq_u32 s3, 5
    s_cbranch_scc1 L_tch14
    s_cmp_eq_u32 s3, 6
    s_cbranch_scc1 L_tch15
    s_cmp_eq_u32 s3, 7
    s_cbranch_scc1 L_tch16
L_touch_ret:
    s_barrier
    s_branch L_head_join
    .p2align 12
L_tch0:
    s_branch L_touch0_ret
L_w0_post:
    s_cmp_eq_u32 s58, 0
    s_cselect_b32 s79, s57, 255
    s_cmp_lt_u32 s57, 22
    s_mov_b32 s6, 0x6e0058
    s_cselect_b32 s6, 0x720048, s6
    s_and_b32 s5, s6, 0xffff
    s_lshr_b32 s6, s6, 16
    s_mul_i32 s7, s58, s6
    s_add_u32 s7, s7, s5
    s_sub_u32 s7, s7, s6
    s_cmp_eq_u32 s58, 0
    s_cselect_b32 s98, 0, s7
    s_cselect_b32 s54, s5, s6
    s_mul_i32 s5, s57, 74
    s_and_b32 s53, s5, 1023
    s_lshl_b32 s10, s57, 9
    s_and_b32 s5, s3, 3
    s_lshl_b32 s5, s5, 7
    s_add_u32 s10, s10, s5
    s_add_u32 s10, s10, 0xc0000
    s_lshl_b32 s52, s57, 21
    v_mov_b32 v62, 0
    v_mov_b32 v63, 4
    v_mov_b32 v2, 0
    s_load_dword s96, s[38:39], 0x0
    s_mov_b32 s40, s18
    s_and_b32 s41, s19, 0xffff
    s_mov_b32 s42, 0x8000000
    s_mov_b32 s43, 0x20000
    s_mov_b32 s44, s20
    s_and_b32 s45, s21, 0xffff
    s_mov_b32 s46, 0x8000000
    s_mov_b32 s47, 0x20000
    s_add_u32 s70, s38, 0x10000
    s_addc_u32 s71, s39, 0
    s_add_u32 s72, s38, 0x54000
    s_addc_u32 s73, s39, 0
    s_add_u32 s74, s38, 0x60000
    s_addc_u32 s75, s39, 0
    s_add_u32 s12, s38, 0x80000
    s_addc_u32 s13, s39, 0
    s_add_u32 s100, s38, s10
    s_addc_u32 s101, s39, 0
    s_mov_b32 s60, 0x05040100
    s_mov_b32 s61, 0x07060302
    s_mov_b32 s62, 0x07060500
    s_mov_b32 s63, 0x07060501
    s_mov_b32 s64, 0x07060502
    s_mov_b32 s65, 0x07060503
    s_mov_b32 s66, 0x0c0c0400
    s_mov_b32 s67, 0x04000c0c
    s_mov_b32 s68, 0x3fb8aa3b
    s_mov_b32 s69, 0x3db504f3
    s_cmp_lg_u32 s58, 0
    s_cbranch_scc1 L_notick
    s_cmp_lt_u32 s57, 22
    s_mov_b32 s5, 858
    s_cselect_b32 s5, 870, s5
    v_add_u32 v230, s5, v3
    v_lshlrev_b32 v232, 7, v3
    s_mov_b64 exec, 15
    global_store_dword v232, v230, s[100:101] sc0 sc1
    s_mov_b64 exec, -1
L_notick:
    s_cmp_eq_u32 s79, 255
    s_cselect_b32 s4, 48, 8
    v_mov_b32 v231, s4
    ds_write_b32 v62, v231 offset:512
    s_waitcnt vmcnt(16)
    v_lshlrev_b32 v128, 16, v144
    v_and_b32 v129, 0xffff0000, v144
    v_lshlrev_b32 v130, 16, v145
    v_and_b32 v131, 0xffff0000, v145
    v_lshlrev_b32 v132, 16, v146
    v_and_b32 v133, 0xffff0000, v146
    v_lshlrev_b32 v134, 16, v147
    v_and_b32 v135, 0xffff0000, v147
    v_lshlrev_b32 v136, 16, v148
    v_and_b32 v137, 0xffff0000, v148
    v_lshlrev_b32 v138, 16, v149
    v_and_b32 v139, 0xffff0000, v149
    v_lshlrev_b32 v140, 16, v150
    v_and_b32 v141, 0xffff0000, v150
    v_lshlrev_b32 v142, 16, v151
    v_and_b32 v143, 0xffff0000, v151
    v_add_f32 v210, v128, v129
    v_add_f32 v211, v132, v133
    v_add_f32 v212, v136, v137
    v_add_f32 v213, v140, v141
    v_add_f32 v210, v210, v130
    v_add_f32 v211, v211, v134
    v_add_f32 v212, v212, v138
    v_add_f32 v213, v213, v142
    v_add_f32 v210, v210, v131
    v_add_f32 v211, v211, v135
    v_add_f32 v212, v212, v139
    v_add_f32 v213, v213, v143
    v_add_f32 v210, v210, v211
    v_add_f32 v212, v212, v213
    v_add_f32 v210, v210, v212
    s_nop 1
    v_add_f32_dpp v210, v210, v210 row_ror:8 row_mask:0xf bank_mask:0xf
    s_nop 1
    v_add_f32_dpp v210, v210, v210 row_ror:4 row_mask:0xf bank_mask:0xf
    s_nop 1
    v_add_f32_dpp v210, v210, v210 row_ror:2 row_mask:0xf bank_mask:0xf
    s_nop 1
    v_add_f32_dpp v210, v210, v210 row_ror:1 row_mask:0xf bank_mask:0xf
    v_mov_b32 v211, v210
    s_nop 1
    v_permlane16_swap_b32 v210, v211
    v_add_f32 v210, v210, v211
    v_mul_f32 v208, 0x3b000000, v210
    v_sub_f32 v128, v128, v208
    v_sub_f32 v129, v129, v208
    v_sub_f32 v130, v130, v208
    v_sub_f32 v131, v131, v208
    v_sub_f32 v132, v132, v208
    v_sub_f32 v133, v133, v208
    v_sub_f32 v134, v134, v208
    v_sub_f32 v135, v135, v208
    v_sub_f32 v136, v136, v208
    v_sub_f32 v137, v137, v208
    v_sub_f32 v138, v138, v208
    v_sub_f32 v139, v139, v208
    v_sub_f32 v140, v140, v208
    v_sub_f32 v141, v141, v208
    v_sub_f32 v142, v142, v208
    v_sub_f32 v143, v143, v208
    v_mul_f32 v210, v128, v128
    v_mul_f32 v211, v129, v129
    v_mul_f32 v212, v130, v130
    v_mul_f32 v213, v131, v131
    v_fmac_f32 v210, v132, v132
    v_fmac_f32 v211, v133, v133
    v_fmac_f32 v212, v134, v134
    v_fmac_f32 v213, v135, v135
    v_fmac_f32 v210, v136, v136
    v_fmac_f32 v211, v137, v137
    v_fmac_f32 v212, v138, v138
    v_fmac_f32 v213, v139, v139
    v_fmac_f32 v210, v140, v140
    v_fmac_f32 v211, v141, v141
    v_fmac_f32 v212, v142, v142
    v_fmac_f32 v213, v143, v143
    v_add_f32 v210, v210, v211
    v_add_f32 v212, v212, v213
    v_add_f32 v210, v210, v212
    s_nop 1
    v_add_f32_dpp v210, v210, v210 row_ror:8 row_mask:0xf bank_mask:0xf
    s_nop 1
    v_add_f32_dpp v210, v210, v210 row_ror:4 row_mask:0xf bank_mask:0xf
    s_nop 1
    v_add_f32_dpp v210, v210, v210 row_ror:2 row_mask:0xf bank_mask:0xf
    s_nop 1
    v_add_f32_dpp v210, v210, v210 row_ror:1 row_mask:0xf bank_mask:0xf
    v_mov_b32 v211, v210
    s_nop 1
    v_permlane16_swap_b32 v210, v211
    v_add_f32 v210, v210, v211
    v_mul_f32 v210, 0x3b000000, v210
    v_cvt_pk_bf16_f32 v210, v210, v210
    v_and_b32 v210, 0xffff0000, v210
    v_add_f32 v210, 0x3727c5ac, v210
    v_cvt_pk_bf16_f32 v210, v210, v210
    v_and_b32 v210, 0xffff0000, v210
    v_sqrt_f32 v210, v210
    s_nop 0
    v_cvt_pk_bf16_f32 v210, v210, v210
    v_and_b32 v210, 0xffff0000, v210
    v_rcp_f32 v209, v210
    v_cvt_pk_bf16_f32 v208, v208, v208
    v_and_b32 v208, 0xffff0000, v208
    v_lshlrev_b32 v210, 16, v152
    v_and_b32 v211, 0xffff0000, v152
    v_sub_f32 v210, v210, v208
    v_sub_f32 v211, v211, v208
    v_cvt_pk_bf16_f32 v210, v210, v211
    v_and_b32 v211, 0xffff0000, v210
    v_lshlrev_b32 v210, 16, v210
    v_mul_f32 v210, v210, v209
    v_mul_f32 v211, v211, v209
    v_cvt_pk_bf16_f32 v152, v210, v211
    v_lshlrev_b32 v227, 5, v227
    ds_bpermute_b32 v160, v227, v152 offset:0
    ds_bpermute_b32 v161, v227, v152 offset:4
    ds_bpermute_b32 v162, v227, v152 offset:8
    ds_bpermute_b32 v163, v227, v152 offset:12
    ds_bpermute_b32 v164, v227, v152 offset:16
    ds_bpermute_b32 v165, v227, v152 offset:20
    ds_bpermute_b32 v166, v227, v152 offset:24
    ds_bpermute_b32 v167, v227, v152 offset:28
    ds_bpermute_b32 v168, v227, v152 offset:128
    ds_bpermute_b32 v169, v227, v152 offset:132
    ds_bpermute_b32 v170, v227, v152 offset:136
    ds_bpermute_b32 v171, v227, v152 offset:140
    s_branch L_tsk2
L_tch1:
    s_branch L_touch0_ret
L_tsk2:
    ds_bpermute_b32 v172, v227, v152 offset:144
    ds_bpermute_b32 v173, v227, v152 offset:148
    ds_bpermute_b32 v174, v227, v152 offset:152
    ds_bpermute_b32 v175, v227, v152 offset:156
    v_mov_b32 v176, 0
    v_mov_b32 v177, 0
    v_mov_b32 v178, 0
    v_mov_b32 v179, 0
    v_mov_b32 v180, 0
    v_mov_b32 v181, 0
    v_mov_b32 v182, 0
    v_mov_b32 v183, 0
    v_mov_b32 v184, 0
    v_mov_b32 v185, 0
    v_mov_b32 v186, 0
    v_mov_b32 v187, 0
    v_mov_b32 v188, 0
    v_mov_b32 v189, 0
    v_mov_b32 v190, 0
    v_mov_b32 v191, 0
    s_waitcnt lgkmcnt(0)
    s_and_b32 s4, s96, 0xff
    s_bfe_u32 s5, s96, 0x80008
    s_or_b32 s5, s5, 1
    s_xor_b32 s5, s4, s5
    s_lshl_b32 s5, s5, 8
    s_or_b32 s4, s4, s5
    s_and_b32 s5, s96, 0xffff00
    s_lshl_b32 s5, s5, 8
    s_or_b32 s59, s4, s5
    v_mov_b32 v58, s59
    s_waitcnt vmcnt(0)
    v_perm_b32 v192, v68, v64, s60
    v_perm_b32 v193, v68, v64, s61
    v_perm_b32 v194, v69, v65, s60
    v_perm_b32 v195, v69, v65, s61
    v_perm_b32 v196, v70, v66, s60
    v_perm_b32 v197, v70, v66, s61
    v_perm_b32 v198, v71, v67, s60
    v_perm_b32 v199, v71, v67, s61
    v_dot2_f32_bf16 v176, v192, v160, v176
    v_dot2_f32_bf16 v177, v193, v160, v177
    v_dot2_f32_bf16 v178, v194, v160, v178
    v_dot2_f32_bf16 v179, v195, v160, v179
    v_dot2_f32_bf16 v180, v196, v160, v180
    v_dot2_f32_bf16 v181, v197, v160, v181
    v_dot2_f32_bf16 v182, v198, v160, v182
    v_dot2_f32_bf16 v183, v199, v160, v183
    v_dot2_f32_bf16 v184, v192, v168, v184
    v_dot2_f32_bf16 v185, v193, v168, v185
    v_dot2_f32_bf16 v186, v194, v168, v186
    v_dot2_f32_bf16 v187, v195, v168, v187
    v_dot2_f32_bf16 v188, v196, v168, v188
    v_dot2_f32_bf16 v189, v197, v168, v189
    v_dot2_f32_bf16 v190, v198, v168, v190
    v_dot2_f32_bf16 v191, v199, v168, v191
    v_perm_b32 v200, v76, v72, s60
    v_perm_b32 v201, v76, v72, s61
    v_perm_b32 v202, v77, v73, s60
    v_perm_b32 v203, v77, v73, s61
    v_perm_b32 v204, v78, v74, s60
    v_perm_b32 v205, v78, v74, s61
    v_perm_b32 v206, v79, v75, s60
    v_perm_b32 v207, v79, v75, s61
    v_dot2_f32_bf16 v176, v200, v161, v176
    v_dot2_f32_bf16 v177, v201, v161, v177
    v_dot2_f32_bf16 v178, v202, v161, v178
    v_dot2_f32_bf16 v179, v203, v161, v179
    v_dot2_f32_bf16 v180, v204, v161, v180
    v_dot2_f32_bf16 v181, v205, v161, v181
    v_dot2_f32_bf16 v182, v206, v161, v182
    v_dot2_f32_bf16 v183, v207, v161, v183
    v_dot2_f32_bf16 v184, v200, v169, v184
    v_dot2_f32_bf16 v185, v201, v169, v185
    v_dot2_f32_bf16 v186, v202, v169, v186
    v_dot2_f32_bf16 v187, v203, v169, v187
    v_dot2_f32_bf16 v188, v204, v169, v188
    v_dot2_f32_bf16 v189, v205, v169, v189
    v_dot2_f32_bf16 v190, v206, v169, v190
    v_dot2_f32_bf16 v191, v207, v169, v191
    v_perm_b32 v192, v84, v80, s60
    v_perm_b32 v193, v84, v80, s61
    v_perm_b32 v194, v85, v81, s60
    v_perm_b32 v195, v85, v81, s61
    v_perm_b32 v196, v86, v82, s60
    v_perm_b32 v197, v86, v82, s61
    v_perm_b32 v198, v87, v83, s60
    v_perm_b32 v199, v87, v83, s61
    v_dot2_f32_bf16 v176, v192, v162, v176
    v_dot2_f32_bf16 v177, v193, v162, v177
    v_dot2_f32_bf16 v178, v194, v162, v178
    v_dot2_f32_bf16 v179, v195, v162, v179
    v_dot2_f32_bf16 v180, v196, v162, v180
    v_dot2_f32_bf16 v181, v197, v162, v181
    v_dot2_f32_bf16 v182, v198, v162, v182
    v_dot2_f32_bf16 v183, v199, v162, v183
    v_dot2_f32_bf16 v184, v192, v170, v184
    v_dot2_f32_bf16 v185, v193, v170, v185
    v_dot2_f32_bf16 v186, v194, v170, v186
    v_dot2_f32_bf16 v187, v195, v170, v187
    v_dot2_f32_bf16 v188, v196, v170, v188
    v_dot2_f32_bf16 v189, v197, v170, v189
    v_dot2_f32_bf16 v190, v198, v170, v190
    v_dot2_f32_bf16 v191, v199, v170, v191
    v_perm_b32 v200, v92, v88, s60
    v_perm_b32 v201, v92, v88, s61
    v_perm_b32 v202, v93, v89, s60
    v_perm_b32 v203, v93, v89, s61
    v_perm_b32 v204, v94, v90, s60
    v_perm_b32 v205, v94, v90, s61
    v_perm_b32 v206, v95, v91, s60
    v_perm_b32 v207, v95, v91, s61
    v_dot2_f32_bf16 v176, v200, v163, v176
    v_dot2_f32_bf16 v177, v201, v163, v177
    v_dot2_f32_bf16 v178, v202, v163, v178
    v_dot2_f32_bf16 v179, v203, v163, v179
    v_dot2_f32_bf16 v180, v204, v163, v180
    v_dot2_f32_bf16 v181, v205, v163, v181
    v_dot2_f32_bf16 v182, v206, v163, v182
    v_dot2_f32_bf16 v183, v207, v163, v183
    v_dot2_f32_bf16 v184, v200, v171, v184
    v_dot2_f32_bf16 v185, v201, v171, v185
    v_dot2_f32_bf16 v186, v202, v171, v186
    v_dot2_f32_bf16 v187, v203, v171, v187
    v_dot2_f32_bf16 v188, v204, v171, v188
    v_dot2_f32_bf16 v189, v205, v171, v189
    v_dot2_f32_bf16 v190, v206, v171, v190
    v_dot2_f32_bf16 v191, v207, v171, v191
    v_perm_b32 v192, v100, v96, s60
    v_perm_b32 v193, v100, v96, s61
    v_perm_b32 v194, v101, v97, s60
    v_perm_b32 v195, v101, v97, s61
    v_perm_b32 v196, v102, v98, s60
    v_perm_b32 v197, v102, v98, s61
    v_perm_b32 v198, v103, v99, s60
    v_perm_b32 v199, v103, v99, s61
    v_dot2_f32_bf16 v176, v192, v164, v176
    v_dot2_f32_bf16 v177, v193, v164, v177
    v_dot2_f32_bf16 v178, v194, v164, v178
    v_dot2_f32_bf16 v179, v195, v164, v179
    v_dot2_f32_bf16 v180, v196, v164, v180
    v_dot2_f32_bf16 v181, v197, v164, v181
    v_dot2_f32_bf16 v182, v198, v164, v182
    v_dot2_f32_bf16 v183, v199, v164, v183
    v_dot2_f32_bf16 v184, v192, v172, v184
    v_dot2_f32_bf16 v185, v193, v172, v185
    v_dot2_f32_bf16 v186, v194, v172, v186
    s_branch L_tsk3
L_tch2:
    s_branch L_touch0_ret
L_tsk3:
    v_dot2_f32_bf16 v187, v195, v172, v187
    v_dot2_f32_bf16 v188, v196, v172, v188
    v_dot2_f32_bf16 v189, v197, v172, v189
    v_dot2_f32_bf16 v190, v198, v172, v190
    v_dot2_f32_bf16 v191, v199, v172, v191
    v_perm_b32 v200, v108, v104, s60
    v_perm_b32 v201, v108, v104, s61
    v_perm_b32 v202, v109, v105, s60
    v_perm_b32 v203, v109, v105, s61
    v_perm_b32 v204, v110, v106, s60
    v_perm_b32 v205, v110, v106, s61
    v_perm_b32 v206, v111, v107, s60
    v_perm_b32 v207, v111, v107, s61
    v_dot2_f32_bf16 v176, v200, v165, v176
    v_dot2_f32_bf16 v177, v201, v165, v177
    v_dot2_f32_bf16 v178, v202, v165, v178
    v_dot2_f32_bf16 v179, v203, v165, v179
    v_dot2_f32_bf16 v180, v204, v165, v180
    v_dot2_f32_bf16 v181, v205, v165, v181
    v_dot2_f32_bf16 v182, v206, v165, v182
    v_dot2_f32_bf16 v183, v207, v165, v183
    v_dot2_f32_bf16 v184, v200, v173, v184
    v_dot2_f32_bf16 v185, v201, v173, v185
    v_dot2_f32_bf16 v186, v202, v173, v186
    v_dot2_f32_bf16 v187, v203, v173, v187
    v_dot2_f32_bf16 v188, v204, v173, v188
    v_dot2_f32_bf16 v189, v205, v173, v189
    v_dot2_f32_bf16 v190, v206, v173, v190
    v_dot2_f32_bf16 v191, v207, v173, v191
    v_perm_b32 v192, v116, v112, s60
    v_perm_b32 v193, v116, v112, s61
    v_perm_b32 v194, v117, v113, s60
    v_perm_b32 v195, v117, v113, s61
    v_perm_b32 v196, v118, v114, s60
    v_perm_b32 v197, v118, v114, s61
    v_perm_b32 v198, v119, v115, s60
    v_perm_b32 v199, v119, v115, s61
    v_dot2_f32_bf16 v176, v192, v166, v176
    v_dot2_f32_bf16 v177, v193, v166, v177
    v_dot2_f32_bf16 v178, v194, v166, v178
    v_dot2_f32_bf16 v179, v195, v166, v179
    v_dot2_f32_bf16 v180, v196, v166, v180
    v_dot2_f32_bf16 v181, v197, v166, v181
    v_dot2_f32_bf16 v182, v198, v166, v182
    v_dot2_f32_bf16 v183, v199, v166, v183
    v_dot2_f32_bf16 v184, v192, v174, v184
    v_dot2_f32_bf16 v185, v193, v174, v185
    v_dot2_f32_bf16 v186, v194, v174, v186
    v_dot2_f32_bf16 v187, v195, v174, v187
    v_dot2_f32_bf16 v188, v196, v174, v188
    v_dot2_f32_bf16 v189, v197, v174, v189
    v_dot2_f32_bf16 v190, v198, v174, v190
    v_dot2_f32_bf16 v191, v199, v174, v191
    v_perm_b32 v200, v124, v120, s60
    v_perm_b32 v201, v124, v120, s61
    v_perm_b32 v202, v125, v121, s60
    v_perm_b32 v203, v125, v121, s61
    v_perm_b32 v204, v126, v122, s60
    v_perm_b32 v205, v126, v122, s61
    v_perm_b32 v206, v127, v123, s60
    v_perm_b32 v207, v127, v123, s61
    v_dot2_f32_bf16 v176, v200, v167, v176
    v_dot2_f32_bf16 v177, v201, v167, v177
    v_dot2_f32_bf16 v178, v202, v167, v178
    v_dot2_f32_bf16 v179, v203, v167, v179
    v_dot2_f32_bf16 v180, v204, v167, v180
    v_dot2_f32_bf16 v181, v205, v167, v181
    v_dot2_f32_bf16 v182, v206, v167, v182
    v_dot2_f32_bf16 v183, v207, v167, v183
    v_dot2_f32_bf16 v184, v200, v175, v184
    v_dot2_f32_bf16 v185, v201, v175, v185
    v_dot2_f32_bf16 v186, v202, v175, v186
    v_dot2_f32_bf16 v187, v203, v175, v187
    v_dot2_f32_bf16 v188, v204, v175, v188
    v_dot2_f32_bf16 v189, v205, v175, v189
    v_dot2_f32_bf16 v190, v206, v175, v190
    v_dot2_f32_bf16 v191, v207, v175, v191
    v_permlane32_swap_b32 v176, v184
    v_permlane32_swap_b32 v177, v185
    v_permlane32_swap_b32 v178, v186
    v_permlane32_swap_b32 v179, v187
    v_permlane32_swap_b32 v180, v188
    v_permlane32_swap_b32 v181, v189
    v_permlane32_swap_b32 v182, v190
    v_permlane32_swap_b32 v183, v191
    v_add_f32 v176, v176, v184
    v_add_f32 v177, v177, v185
    v_add_f32 v178, v178, v186
    v_add_f32 v179, v179, v187
    v_add_f32 v180, v180, v188
    v_add_f32 v181, v181, v189
    v_add_f32 v182, v182, v190
    v_add_f32 v183, v183, v191
    v_permlane16_swap_b32 v176, v180
    v_permlane16_swap_b32 v177, v181
    v_permlane16_swap_b32 v178, v182
    v_permlane16_swap_b32 v179, v183
    v_add_f32 v176, v176, v180
    v_add_f32 v177, v177, v181
    v_add_f32 v178, v178, v182
    v_add_f32 v179, v179, v183
    v_perm_b32 v176, v176, v58, s62
    v_perm_b32 v177, v177, v58, s63
    v_perm_b32 v178, v178, v58, s64
    v_perm_b32 v179, v179, v58, s65
    v_lshrrev_b32 v224, 5, v3
    v_lshlrev_b32 v224, 9, v224
    v_bfe_u32 v225, v3, 4, 1
    v_lshl_add_u32 v224, v225, 4, v224
    v_lshl_add_u32 v224, v229, 5, v224
    s_lshl_b32 s4, s57, 3
    s_add_u32 s4, s4, s58
    s_lshl_b32 s4, s4, 10
    v_add_u32 v224, s4, v224
    global_store_dwordx4 v224, v[176:179], s[12:13] sc1
    s_lshl_b32 s4, s57, 13
    s_add_u32 s76, s12, s4
    s_addc_u32 s77, s13, 0
    v_add_u32 v160, 4096, v1
    s_and_b32 s14, s59, 0xff
    s_bfe_u32 s15, s59, 0x80008
    s_mov_b32 s78, 0
L_spin_Q:
    s_load_dwordx2 s[0:1], s[76:77], 0x3f0 glc
    s_load_dwordx2 s[4:5], s[76:77], 0x7f0 glc
    s_load_dwordx2 s[6:7], s[76:77], 0xbf0 glc
    s_load_dwordx2 s[8:9], s[76:77], 0xff0 glc
    s_load_dwordx2 s[10:11], s[76:77], 0x13f0 glc
    s_load_dwordx2 s[26:27], s[76:77], 0x17f0 glc
    s_load_dwordx2 s[36:37], s[76:77], 0x1bf0 glc
    s_load_dwordx2 s[22:23], s[76:77], 0x1ff0 glc
    s_waitcnt lgkmcnt(0)
    s_xor_b64 s[0:1], s[0:1], s[14:15]
    s_xor_b64 s[4:5], s[4:5], s[14:15]
    s_xor_b64 s[6:7], s[6:7], s[14:15]
    s_xor_b64 s[8:9], s[8:9], s[14:15]
    s_xor_b64 s[10:11], s[10:11], s[14:15]
    s_xor_b64 s[26:27], s[26:27], s[14:15]
    s_xor_b64 s[36:37], s[36:37], s[14:15]
    s_xor_b64 s[22:23], s[22:23], s[14:15]
    s_or_b64 s[0:1], s[0:1], s[10:11]
    s_or_b64 s[4:5], s[4:5], s[26:27]
    s_or_b64 s[6:7], s[6:7], s[36:37]
    s_or_b64 s[8:9], s[8:9], s[22:23]
    s_or_b64 s[0:1], s[0:1], s[6:7]
    s_or_b64 s[4:5], s[4:5], s[8:9]
    s_or_b64 s[0:1], s[0:1], s[4:5]
    s_or_b32 s0, s0, s1
    s_and_b32 s0, s0, 0xff
    s_cbranch_scc0 L_spinok_Q
    s_add_u32 s78, s78, 1
    s_cmp_lt_u32 s78, 8192
    s_cbranch_scc1 L_spin_Q
L_spinok_Q:
    s_mov_b32 s78, 0
L_poll_Q:
    global_load_dwordx4 v[128:131], v1, s[76:77] offset:0 sc1
    global_load_dwordx4 v[132:135], v1, s[76:77] offset:1024 sc1
    global_load_dwordx4 v[136:139], v1, s[76:77] offset:2048 sc1
    global_load_dwordx4 v[140:143], v1, s[76:77] offset:3072 sc1
    global_load_dwordx4 v[144:147], v160, s[76:77] offset:0 sc1
    global_load_dwordx4 v[148:151], v160, s[76:77] offset:1024 sc1
    global_load_dwordx4 v[152:155], v160, s[76:77] offset:2048 sc1
    global_load_dwordx4 v[156:159], v160, s[76:77] offset:3072 sc1
    s_waitcnt vmcnt(0)
    v_perm_b32 v161, v129, v128, s66
    s_branch L_tsk4
L_tch3:
    s_branch L_touch0_ret
L_tsk4:
    v_perm_b32 v162, v131, v130, s67
    v_or_b32 v161, v161, v162
    v_xor_b32 v2, v161, v58
    v_perm_b32 v161, v133, v132, s66
    v_perm_b32 v162, v135, v134, s67
    v_or_b32 v161, v161, v162
    v_xor_b32 v161, v161, v58
    v_or_b32 v2, v2, v161
    v_perm_b32 v161, v137, v136, s66
    v_perm_b32 v162, v139, v138, s67
    v_or_b32 v161, v161, v162
    v_xor_b32 v161, v161, v58
    v_or_b32 v2, v2, v161
    v_perm_b32 v161, v141, v140, s66
    v_perm_b32 v162, v143, v142, s67
    v_or_b32 v161, v161, v162
    v_xor_b32 v161, v161, v58
    v_or_b32 v2, v2, v161
    v_perm_b32 v161, v145, v144, s66
    v_perm_b32 v162, v147, v146, s67
    v_or_b32 v161, v161, v162
    v_xor_b32 v161, v161, v58
    v_or_b32 v2, v2, v161
    v_perm_b32 v161, v149, v148, s66
    v_perm_b32 v162, v151, v150, s67
    v_or_b32 v161, v161, v162
    v_xor_b32 v161, v161, v58
    v_or_b32 v2, v2, v161
    v_perm_b32 v161, v153, v152, s66
    v_perm_b32 v162, v155, v154, s67
    v_or_b32 v161, v161, v162
    v_xor_b32 v161, v161, v58
    v_or_b32 v2, v2, v161
    v_perm_b32 v161, v157, v156, s66
    v_perm_b32 v162, v159, v158, s67
    v_or_b32 v161, v161, v162
    v_xor_b32 v161, v161, v58
    v_or_b32 v2, v2, v161
    v_cmp_ne_u32 vcc, 0, v2
    s_cmp_eq_u64 vcc, 0
    s_cbranch_scc1 L_pollok_Q
    s_add_u32 s78, s78, 1
    s_cmp_lt_u32 s78, 8192
    s_cbranch_scc1 L_poll_Q
L_pollok_Q:
    v_add_f32 v128, v128, v144
    v_add_f32 v129, v129, v145
    v_add_f32 v130, v130, v146
    v_add_f32 v131, v131, v147
    v_add_f32 v132, v132, v148
    v_add_f32 v133, v133, v149
    v_add_f32 v134, v134, v150
    v_add_f32 v135, v135, v151
    v_add_f32 v136, v136, v152
    v_add_f32 v137, v137, v153
    v_add_f32 v138, v138, v154
    v_add_f32 v139, v139, v155
    v_add_f32 v140, v140, v156
    v_add_f32 v141, v141, v157
    v_add_f32 v142, v142, v158
    v_add_f32 v143, v143, v159
    v_add_f32 v128, v128, v136
    v_add_f32 v129, v129, v137
    v_add_f32 v130, v130, v138
    v_add_f32 v131, v131, v139
    v_add_f32 v132, v132, v140
    v_add_f32 v133, v133, v141
    v_add_f32 v134, v134, v142
    v_add_f32 v135, v135, v143
    v_add_f32 v128, v128, v132
    v_add_f32 v129, v129, v133
    v_add_f32 v130, v130, v134
    v_add_f32 v131, v131, v135
    v_cvt_pk_bf16_f32 v136, v128, v129
    v_cvt_pk_bf16_f32 v137, v130, v131
    v_lshlrev_b32 v160, 3, v3
    ds_write_b64 v160, v[136:137] offset:0
    s_waitcnt lgkmcnt(0)
    s_barrier
    s_cmp_eq_u32 s79, 255
    s_cbranch_scc1 L_ft_plain0
    s_lshl_b32 s4, s3, 1
    s_add_u32 s4, s4, s98
    s_add_u32 s5, s4, s53
    s_and_b32 s5, s5, 1023
    s_and_b32 s11, s5, 15
    s_mul_i32 s11, s11, 17
    s_bfe_u32 s11, s11, 0x40001
    s_andn2_b32 s5, s5, 15
    s_or_b32 s5, s5, s11
    s_andn2_b32 s11, s5, 63
    s_add_u32 s5, s5, s11
    s_lshl_b32 s5, s5, 10
    s_add_u32 s55, s5, s52
    s_xor_b32 s56, s55, 0x4000800
    buffer_load_dwordx4 v[128:131], v1, s[40:43], s55 offen nt
    buffer_load_dwordx4 v[132:135], v55, s[40:43], s55 offen nt
    buffer_load_dwordx4 v[136:139], v1, s[40:43], s56 offen nt
    buffer_load_dwordx4 v[140:143], v55, s[40:43], s56 offen nt
    buffer_load_dwordx4 v[160:163], v1, s[44:47], s55 offen nt
    buffer_load_dwordx4 v[164:167], v55, s[44:47], s55 offen nt
    buffer_load_dwordx4 v[168:171], v1, s[44:47], s56 offen nt
    buffer_load_dwordx4 v[172:175], v55, s[44:47], s56 offen nt
    s_add_u32 s55, s55, 0x2000
    s_xor_b32 s56, s55, 0x4000800
    buffer_load_dwordx4 v[144:147], v1, s[40:43], s55 offen nt
    buffer_load_dwordx4 v[148:151], v55, s[40:43], s55 offen nt
    buffer_load_dwordx4 v[152:155], v1, s[40:43], s56 offen nt
    buffer_load_dwordx4 v[156:159], v55, s[40:43], s56 offen nt
    buffer_load_dwordx4 v[176:179], v1, s[44:47], s55 offen nt
    buffer_load_dwordx4 v[180:183], v55, s[44:47], s55 offen nt
    buffer_load_dwordx4 v[184:187], v1, s[44:47], s56 offen nt
    buffer_load_dwordx4 v[188:191], v55, s[44:47], s56 offen nt
L_ft_w0:
    s_mov_b32 s48, s24
    s_and_b32 s49, s25, 0xffff
    s_mov_b32 s50, 0x400000
    s_mov_b32 s51, 0x20000
    v_bfe_u32 v42, v3, 3, 1
    v_lshlrev_b32 v42, 5, v42
    v_lshrrev_b32 v43, 4, v3
    v_lshl_add_u32 v42, v43, 3, v42
    v_mul_u32_u24 v42, 1024, v42
    v_and_b32 v43, 7, v3
    v_lshl_add_u32 v46, v43, 4, v42
    s_lshr_b32 s4, s79, 3
    s_lshl_b32 s4, s4, 3
    s_add_u32 s4, s4, s3
    s_lshl_b32 s4, s4, 17
    s_and_b32 s5, s79, 7
    s_lshl_b32 s5, s5, 7
    s_add_u32 s4, s4, s5
    buffer_load_dwordx4 v[64:67], v46, s[48:51], s4 offen nt
    s_add_u32 s4, s4, 1024
    buffer_load_dwordx4 v[68:71], v46, s[48:51], s4 offen nt
    s_add_u32 s4, s4, 1024
    buffer_load_dwordx4 v[72:75], v46, s[48:51], s4 offen nt
    s_add_u32 s4, s4, 1024
    buffer_load_dwordx4 v[76:79], v46, s[48:51], s4 offen nt
    s_add_u32 s4, s4, 1024
    buffer_load_dwordx4 v[80:83], v46, s[48:51], s4 offen nt
    s_add_u32 s4, s4, 1024
    buffer_load_dwordx4 v[84:87], v46, s[48:51], s4 offen nt
    s_add_u32 s4, s4, 1024
    buffer_load_dwordx4 v[88:91], v46, s[48:51], s4 offen nt
    s_add_u32 s4, s4, 1024
    s_branch L_tsk5
L_tch4:
    s_branch L_touch0_ret
L_tsk5:
    buffer_load_dwordx4 v[92:95], v46, s[48:51], s4 offen nt
    s_add_u32 s4, s4, 58368
    buffer_load_dwordx4 v[96:99], v46, s[48:51], s4 offen nt
    s_add_u32 s4, s4, 1024
    buffer_load_dwordx4 v[100:103], v46, s[48:51], s4 offen nt
    s_add_u32 s4, s4, 1024
    buffer_load_dwordx4 v[104:107], v46, s[48:51], s4 offen nt
    s_add_u32 s4, s4, 1024
    buffer_load_dwordx4 v[108:111], v46, s[48:51], s4 offen nt
    s_add_u32 s4, s4, 1024
    buffer_load_dwordx4 v[112:115], v46, s[48:51], s4 offen nt
    s_add_u32 s4, s4, 1024
    buffer_load_dwordx4 v[116:119], v46, s[48:51], s4 offen nt
    s_add_u32 s4, s4, 1024
    buffer_load_dwordx4 v[120:123], v46, s[48:51], s4 offen nt
    s_add_u32 s4, s4, 1024
    buffer_load_dwordx4 v[124:127], v46, s[48:51], s4 offen nt
    s_cmp_ge_u32 s79, 22
    s_cbranch_scc1 L_pf_done0
    s_cmp_lt_u32 s3, 4
    s_cselect_b32 s6, s28, s30
    s_cselect_b32 s7, s29, s31
    s_mov_b32 s48, s6
    s_and_b32 s49, s7, 0xffff
    s_mov_b32 s50, 0x158000
    s_mov_b32 s51, 0x20000
    v_bfe_u32 v42, v3, 3, 1
    v_lshlrev_b32 v42, 5, v42
    v_lshrrev_b32 v43, 4, v3
    v_lshl_add_u32 v42, v43, 3, v42
    v_mul_u32_u24 v42, 2752, v42
    v_and_b32 v43, 7, v3
    v_lshl_add_u32 v46, v43, 4, v42
    s_and_b32 s4, s3, 3
    s_mul_i32 s4, s4, 352256
    s_lshl_b32 s5, s79, 7
    s_add_u32 s4, s4, s5
    buffer_load_dwordx4 v[192:195], v46, s[48:51], s4 offen nt
    s_add_u32 s4, s4, 2752
    buffer_load_dwordx4 v[196:199], v46, s[48:51], s4 offen nt
    s_add_u32 s4, s4, 2752
    buffer_load_dwordx4 v[200:203], v46, s[48:51], s4 offen nt
    s_add_u32 s4, s4, 2752
    buffer_load_dwordx4 v[204:207], v46, s[48:51], s4 offen nt
    s_add_u32 s4, s4, 2752
    buffer_load_dwordx4 v[208:211], v46, s[48:51], s4 offen nt
    s_add_u32 s4, s4, 2752
    buffer_load_dwordx4 v[212:215], v46, s[48:51], s4 offen nt
    s_add_u32 s4, s4, 2752
    buffer_load_dwordx4 v[216:219], v46, s[48:51], s4 offen nt
    s_add_u32 s4, s4, 2752
    buffer_load_dwordx4 v[220:223], v46, s[48:51], s4 offen nt
    s_add_u32 s4, s4, 156864
    buffer_load_dwordx4 v[224:227], v46, s[48:51], s4 offen nt
    s_add_u32 s4, s4, 2752
    buffer_load_dwordx4 v[228:231], v46, s[48:51], s4 offen nt
    s_add_u32 s4, s4, 2752
    buffer_load_dwordx4 v[232:235], v46, s[48:51], s4 offen nt
    s_add_u32 s4, s4, 2752
    buffer_load_dwordx4 v[236:239], v46, s[48:51], s4 offen nt
    s_add_u32 s4, s4, 2752
    buffer_load_dwordx4 v[240:243], v46, s[48:51], s4 offen nt
    s_add_u32 s4, s4, 2752
    buffer_load_dwordx4 v[244:247], v46, s[48:51], s4 offen nt
    s_add_u32 s4, s4, 2752
    buffer_load_dwordx4 v[248:251], v46, s[48:51], s4 offen nt
    s_add_u32 s4, s4, 2752
    buffer_load_dwordx4 v[252:255], v46, s[48:51], s4 offen nt
L_pf_done0:
    s_branch L_ft_done0
L_ft_plain0:
    s_lshl_b32 s4, s3, 1
    s_add_u32 s4, s4, s98
    s_add_u32 s5, s4, s53
    s_and_b32 s5, s5, 1023
    s_and_b32 s11, s5, 15
    s_mul_i32 s11, s11, 17
    s_bfe_u32 s11, s11, 0x40001
    s_andn2_b32 s5, s5, 15
    s_or_b32 s5, s5, s11
    s_andn2_b32 s11, s5, 63
    s_add_u32 s5, s5, s11
    s_lshl_b32 s5, s5, 10
    s_add_u32 s55, s5, s52
    s_xor_b32 s56, s55, 0x4000800
    buffer_load_dwordx4 v[128:131], v1, s[40:43], s55 offen nt
    buffer_load_dwordx4 v[132:135], v55, s[40:43], s55 offen nt
    buffer_load_dwordx4 v[136:139], v1, s[40:43], s56 offen nt
    buffer_load_dwordx4 v[140:143], v55, s[40:43], s56 offen nt
    buffer_load_dwordx4 v[160:163], v1, s[44:47], s55 offen nt
    buffer_load_dwordx4 v[164:167], v55, s[44:47], s55 offen nt
    buffer_load_dwordx4 v[168:171], v1, s[44:47], s56 offen nt
    buffer_load_dwordx4 v[172:175], v55, s[44:47], s56 offen nt
    s_add_u32 s55, s55, 0x2000
    s_xor_b32 s56, s55, 0x4000800
    buffer_load_dwordx4 v[144:147], v1, s[40:43], s55 offen nt
    buffer_load_dwordx4 v[148:151], v55, s[40:43], s55 offen nt
    buffer_load_dwordx4 v[152:155], v1, s[40:43], s56 offen nt
    buffer_load_dwordx4 v[156:159], v55, s[40:43], s56 offen nt
    buffer_load_dwordx4 v[176:179], v1, s[44:47], s55 offen nt
    buffer_load_dwordx4 v[180:183], v55, s[44:47], s55 offen nt
    buffer_load_dwordx4 v[184:187], v1, s[44:47], s56 offen nt
    buffer_load_dwordx4 v[188:191], v55, s[44:47], s56 offen nt
    s_lshl_b32 s4, s3, 1
    s_add_u32 s4, s4, s98
    s_add_u32 s4, s4, 32
    s_add_u32 s5, s4, s53
    s_and_b32 s5, s5, 1023
    s_and_b32 s11, s5, 15
    s_mul_i32 s11, s11, 17
    s_bfe_u32 s11, s11, 0x40001
    s_andn2_b32 s5, s5, 15
    s_or_b32 s5, s5, s11
    s_andn2_b32 s11, s5, 63
    s_add_u32 s5, s5, s11
    s_lshl_b32 s5, s5, 10
    s_add_u32 s55, s5, s52
    s_xor_b32 s56, s55, 0x4000800
    buffer_load_dwordx4 v[64:67], v1, s[40:43], s55 offen nt
    buffer_load_dwordx4 v[68:71], v55, s[40:43], s55 offen nt
    buffer_load_dwordx4 v[72:75], v1, s[40:43], s56 offen nt
    buffer_load_dwordx4 v[76:79], v55, s[40:43], s56 offen nt
    buffer_load_dwordx4 v[96:99], v1, s[44:47], s55 offen nt
    buffer_load_dwordx4 v[100:103], v55, s[44:47], s55 offen nt
    buffer_load_dwordx4 v[104:107], v1, s[44:47], s56 offen nt
    buffer_load_dwordx4 v[108:111], v55, s[44:47], s56 offen nt
    s_add_u32 s55, s55, 0x2000
    s_xor_b32 s56, s55, 0x4000800
    buffer_load_dwordx4 v[80:83], v1, s[40:43], s55 offen nt
    buffer_load_dwordx4 v[84:87], v55, s[40:43], s55 offen nt
    buffer_load_dwordx4 v[88:91], v1, s[40:43], s56 offen nt
    buffer_load_dwordx4 v[92:95], v55, s[40:43], s56 offen nt
    buffer_load_dwordx4 v[112:115], v1, s[44:47], s55 offen nt
    buffer_load_dwordx4 v[116:119], v55, s[44:47], s55 offen nt
    buffer_load_dwordx4 v[120:123], v1, s[44:47], s56 offen nt
    buffer_load_dwordx4 v[124:127], v55, s[44:47], s56 offen nt
    s_lshl_b32 s4, s3, 1
    s_add_u32 s4, s4, s98
    s_add_u32 s4, s4, 16
    s_add_u32 s5, s4, s53
    s_and_b32 s5, s5, 1023
    s_and_b32 s11, s5, 15
    s_mul_i32 s11, s11, 17
    s_bfe_u32 s11, s11, 0x40001
    s_andn2_b32 s5, s5, 15
    s_or_b32 s5, s5, s11
    s_andn2_b32 s11, s5, 63
    s_add_u32 s5, s5, s11
    s_lshl_b32 s5, s5, 10
    s_add_u32 s55, s5, s52
    s_xor_b32 s56, s55, 0x4000800
    buffer_load_dwordx4 v[192:195], v1, s[40:43], s55 offen nt
    buffer_load_dwordx4 v[196:199], v55, s[40:43], s55 offen nt
    buffer_load_dwordx4 v[200:203], v1, s[40:43], s56 offen nt
    buffer_load_dwordx4 v[204:207], v55, s[40:43], s56 offen nt
    buffer_load_dwordx4 v[224:227], v1, s[44:47], s55 offen nt
    buffer_load_dwordx4 v[228:231], v55, s[44:47], s55 offen nt
    buffer_load_dwordx4 v[232:235], v1, s[44:47], s56 offen nt
    buffer_load_dwordx4 v[236:239], v55, s[44:47], s56 offen nt
    s_add_u32 s55, s55, 0x2000
    s_xor_b32 s56, s55, 0x4000800
    s_branch L_tsk6
L_tch5:
    s_branch L_touch0_ret
L_tsk6:
    buffer_load_dwordx4 v[208:211], v1, s[40:43], s55 offen nt
    buffer_load_dwordx4 v[212:215], v55, s[40:43], s55 offen nt
    buffer_load_dwordx4 v[216:219], v1, s[40:43], s56 offen nt
    buffer_load_dwordx4 v[220:223], v55, s[40:43], s56 offen nt
    buffer_load_dwordx4 v[240:243], v1, s[44:47], s55 offen nt
    buffer_load_dwordx4 v[244:247], v55, s[44:47], s55 offen nt
    buffer_load_dwordx4 v[248:251], v1, s[44:47], s56 offen nt
    buffer_load_dwordx4 v[252:255], v55, s[44:47], s56 offen nt
L_ft_done0:
    s_branch L_head_join
L_head_join:
    v_and_b32 v42, 15, v3
    v_lshlrev_b32 v42, 4, v42
    ds_read_b128 v[4:7], v42 offset:0
    ds_read_b128 v[8:11], v42 offset:256
    v_mov_b32 v12, 0xff7fffff
    v_mov_b32 v13, 0
    v_mov_b32 v16, 0
    v_mov_b32 v17, 0
    v_mov_b32 v18, 0
    v_mov_b32 v19, 0
    v_mov_b32 v20, 0
    v_mov_b32 v21, 0
    v_mov_b32 v22, 0
    v_mov_b32 v23, 0
    v_mov_b32 v14, 0xff7fffff
    v_mov_b32 v15, 0
    v_mov_b32 v24, 0
    v_mov_b32 v25, 0
    v_mov_b32 v26, 0
    v_mov_b32 v27, 0
    v_mov_b32 v28, 0
    v_mov_b32 v29, 0
    v_mov_b32 v30, 0
    v_mov_b32 v31, 0
    v_mov_b32 v57, 1
    s_waitcnt lgkmcnt(0)
    s_cmp_lt_u32 s3, 4
    s_cbranch_scc1 L_stream
    s_waitcnt vmcnt(0)
    s_cmp_eq_u32 s79, 255
    s_cbranch_scc1 L_help_plain
    v_perm_b32 v42, v68, v64, s60
    v_perm_b32 v68, v68, v64, s61
    v_mov_b32 v64, v42
    v_perm_b32 v42, v69, v65, s60
    v_perm_b32 v43, v69, v65, s61
    v_perm_b32 v65, v76, v72, s60
    v_perm_b32 v69, v76, v72, s61
    v_mov_b32 v72, v42
    v_mov_b32 v76, v43
    v_perm_b32 v42, v70, v66, s60
    v_perm_b32 v43, v70, v66, s61
    v_perm_b32 v66, v84, v80, s60
    v_perm_b32 v70, v84, v80, s61
    v_mov_b32 v80, v42
    v_mov_b32 v84, v43
    v_perm_b32 v42, v71, v67, s60
    v_perm_b32 v43, v71, v67, s61
    v_perm_b32 v67, v92, v88, s60
    v_perm_b32 v71, v92, v88, s61
    v_mov_b32 v88, v42
    v_mov_b32 v92, v43
    v_perm_b32 v42, v77, v73, s60
    v_perm_b32 v77, v77, v73, s61
    v_mov_b32 v73, v42
    v_perm_b32 v42, v78, v74, s60
    v_perm_b32 v43, v78, v74, s61
    v_perm_b32 v74, v85, v81, s60
    v_perm_b32 v78, v85, v81, s61
    v_mov_b32 v81, v42
    v_mov_b32 v85, v43
    v_perm_b32 v42, v79, v75, s60
    v_perm_b32 v43, v79, v75, s61
    v_perm_b32 v75, v93, v89, s60
    v_perm_b32 v79, v93, v89, s61
    v_mov_b32 v89, v42
    v_mov_b32 v93, v43
    v_perm_b32 v42, v86, v82, s60
    v_perm_b32 v86, v86, v82, s61
    v_mov_b32 v82, v42
    v_perm_b32 v42, v87, v83, s60
    v_perm_b32 v43, v87, v83, s61
    v_perm_b32 v83, v94, v90, s60
    v_perm_b32 v87, v94, v90, s61
    v_mov_b32 v90, v42
    v_mov_b32 v94, v43
    v_perm_b32 v42, v95, v91, s60
    v_perm_b32 v95, v95, v91, s61
    v_mov_b32 v91, v42
    v_perm_b32 v42, v100, v96, s60
    v_perm_b32 v100, v100, v96, s61
    v_mov_b32 v96, v42
    v_perm_b32 v42, v101, v97, s60
    v_perm_b32 v43, v101, v97, s61
    v_perm_b32 v97, v108, v104, s60
    v_perm_b32 v101, v108, v104, s61
    v_mov_b32 v104, v42
    v_mov_b32 v108, v43
    v_perm_b32 v42, v102, v98, s60
    v_perm_b32 v43, v102, v98, s61
    v_perm_b32 v98, v116, v112, s60
    v_perm_b32 v102, v116, v112, s61
    v_mov_b32 v112, v42
    v_mov_b32 v116, v43
    v_perm_b32 v42, v103, v99, s60
    v_perm_b32 v43, v103, v99, s61
    v_perm_b32 v99, v124, v120, s60
    v_perm_b32 v103, v124, v120, s61
    v_mov_b32 v120, v42
    v_mov_b32 v124, v43
    v_perm_b32 v42, v109, v105, s60
    v_perm_b32 v109, v109, v105, s61
    v_mov_b32 v105, v42
    v_perm_b32 v42, v110, v106, s60
    v_perm_b32 v43, v110, v106, s61
    v_perm_b32 v106, v117, v113, s60
    v_perm_b32 v110, v117, v113, s61
    v_mov_b32 v113, v42
    v_mov_b32 v117, v43
    v_perm_b32 v42, v111, v107, s60
    v_perm_b32 v43, v111, v107, s61
    v_perm_b32 v107, v125, v121, s60
    v_perm_b32 v111, v125, v121, s61
    v_mov_b32 v121, v42
    v_mov_b32 v125, v43
    v_perm_b32 v42, v118, v114, s60
    v_perm_b32 v118, v118, v114, s61
    v_mov_b32 v114, v42
    v_perm_b32 v42, v119, v115, s60
    v_perm_b32 v43, v119, v115, s61
    v_perm_b32 v115, v126, v122, s60
    v_perm_b32 v119, v126, v122, s61
    v_mov_b32 v122, v42
    v_mov_b32 v126, v43
    v_perm_b32 v42, v127, v123, s60
    v_perm_b32 v127, v127, v123, s61
    v_mov_b32 v123, v42
    s_cmp_ge_u32 s79, 22
    s_cbranch_scc1 L_tr_doneH
    v_perm_b32 v42, v196, v192, s60
    v_perm_b32 v196, v196, v192, s61
    v_mov_b32 v192, v42
    v_perm_b32 v42, v197, v193, s60
    v_perm_b32 v43, v197, v193, s61
    v_perm_b32 v193, v204, v200, s60
    v_perm_b32 v197, v204, v200, s61
    v_mov_b32 v200, v42
    v_mov_b32 v204, v43
    v_perm_b32 v42, v198, v194, s60
    v_perm_b32 v43, v198, v194, s61
    v_perm_b32 v194, v212, v208, s60
    v_perm_b32 v198, v212, v208, s61
    v_mov_b32 v208, v42
    v_mov_b32 v212, v43
    v_perm_b32 v42, v199, v195, s60
    v_perm_b32 v43, v199, v195, s61
    v_perm_b32 v195, v220, v216, s60
    v_perm_b32 v199, v220, v216, s61
    v_mov_b32 v216, v42
    v_mov_b32 v220, v43
    v_perm_b32 v42, v205, v201, s60
    v_perm_b32 v205, v205, v201, s61
    v_mov_b32 v201, v42
    v_perm_b32 v42, v206, v202, s60
    v_perm_b32 v43, v206, v202, s61
    v_perm_b32 v202, v213, v209, s60
    v_perm_b32 v206, v213, v209, s61
    v_mov_b32 v209, v42
    v_mov_b32 v213, v43
    v_perm_b32 v42, v207, v203, s60
    v_perm_b32 v43, v207, v203, s61
    v_perm_b32 v203, v221, v217, s60
    v_perm_b32 v207, v221, v217, s61
    v_mov_b32 v217, v42
    v_mov_b32 v221, v43
    v_perm_b32 v42, v214, v210, s60
    v_perm_b32 v214, v214, v210, s61
    v_mov_b32 v210, v42
    v_perm_b32 v42, v215, v211, s60
    v_perm_b32 v43, v215, v211, s61
    v_perm_b32 v211, v222, v218, s60
    v_perm_b32 v215, v222, v218, s61
    v_mov_b32 v218, v42
    v_mov_b32 v222, v43
    v_perm_b32 v42, v223, v219, s60
    v_perm_b32 v223, v223, v219, s61
    v_mov_b32 v219, v42
    v_perm_b32 v42, v228, v224, s60
    v_perm_b32 v228, v228, v224, s61
    v_mov_b32 v224, v42
    v_perm_b32 v42, v229, v225, s60
    v_perm_b32 v43, v229, v225, s61
    v_perm_b32 v225, v236, v232, s60
    v_perm_b32 v229, v236, v232, s61
    v_mov_b32 v232, v42
    v_mov_b32 v236, v43
    v_perm_b32 v42, v230, v226, s60
    v_perm_b32 v43, v230, v226, s61
    v_perm_b32 v226, v244, v240, s60
    v_perm_b32 v230, v244, v240, s61
    v_mov_b32 v240, v42
    v_mov_b32 v244, v43
    v_perm_b32 v42, v231, v227, s60
    v_perm_b32 v43, v231, v227, s61
    v_perm_b32 v227, v252, v248, s60
    v_perm_b32 v231, v252, v248, s61
    v_mov_b32 v248, v42
    v_mov_b32 v252, v43
    v_perm_b32 v42, v237, v233, s60
    v_perm_b32 v237, v237, v233, s61
    v_mov_b32 v233, v42
    v_perm_b32 v42, v238, v234, s60
    v_perm_b32 v43, v238, v234, s61
    v_perm_b32 v234, v245, v241, s60
    v_perm_b32 v238, v245, v241, s61
    v_mov_b32 v241, v42
    v_mov_b32 v245, v43
    v_perm_b32 v42, v239, v235, s60
    v_perm_b32 v43, v239, v235, s61
    v_perm_b32 v235, v253, v249, s60
    v_perm_b32 v239, v253, v249, s61
    v_mov_b32 v249, v42
    v_mov_b32 v253, v43
    v_perm_b32 v42, v246, v242, s60
    v_perm_b32 v246, v246, v242, s61
    v_mov_b32 v242, v42
    v_perm_b32 v42, v247, v243, s60
    v_perm_b32 v43, v247, v243, s61
    v_perm_b32 v243, v254, v250, s60
    v_perm_b32 v247, v254, v250, s61
    v_mov_b32 v250, v42
    v_mov_b32 v254, v43
    v_perm_b32 v42, v255, v251, s60
    v_perm_b32 v255, v255, v251, s61
    v_mov_b32 v251, v42
    v_perm_b32 v42, v132, v128, s60
    v_perm_b32 v132, v132, v128, s61
    v_mov_b32 v128, v42
    v_perm_b32 v42, v133, v129, s60
    v_perm_b32 v43, v133, v129, s61
    v_perm_b32 v129, v140, v136, s60
    v_perm_b32 v133, v140, v136, s61
    v_mov_b32 v136, v42
    v_mov_b32 v140, v43
    v_perm_b32 v42, v134, v130, s60
    v_perm_b32 v43, v134, v130, s61
    v_perm_b32 v130, v148, v144, s60
    v_perm_b32 v134, v148, v144, s61
    v_mov_b32 v144, v42
    v_mov_b32 v148, v43
    v_perm_b32 v42, v135, v131, s60
    v_perm_b32 v43, v135, v131, s61
    v_perm_b32 v131, v156, v152, s60
    v_perm_b32 v135, v156, v152, s61
    v_mov_b32 v152, v42
    v_mov_b32 v156, v43
    v_perm_b32 v42, v141, v137, s60
    v_perm_b32 v141, v141, v137, s61
    v_mov_b32 v137, v42
    v_perm_b32 v42, v142, v138, s60
    v_perm_b32 v43, v142, v138, s61
    v_perm_b32 v138, v149, v145, s60
    v_perm_b32 v142, v149, v145, s61
    v_mov_b32 v145, v42
    v_mov_b32 v149, v43
    v_perm_b32 v42, v143, v139, s60
    v_perm_b32 v43, v143, v139, s61
    v_perm_b32 v139, v157, v153, s60
    v_perm_b32 v143, v157, v153, s61
    v_mov_b32 v153, v42
    v_mov_b32 v157, v43
    v_perm_b32 v42, v150, v146, s60
    v_perm_b32 v150, v150, v146, s61
    v_mov_b32 v146, v42
    v_perm_b32 v42, v151, v147, s60
    v_perm_b32 v43, v151, v147, s61
    v_perm_b32 v147, v158, v154, s60
    v_perm_b32 v151, v158, v154, s61
    v_mov_b32 v154, v42
    v_mov_b32 v158, v43
    v_perm_b32 v42, v159, v155, s60
    v_perm_b32 v159, v159, v155, s61
    v_mov_b32 v155, v42
    v_perm_b32 v42, v164, v160, s60
    v_perm_b32 v164, v164, v160, s61
    v_mov_b32 v160, v42
    v_perm_b32 v42, v165, v161, s60
    v_perm_b32 v43, v165, v161, s61
    v_perm_b32 v161, v172, v168, s60
    v_perm_b32 v165, v172, v168, s61
    v_mov_b32 v168, v42
    v_mov_b32 v172, v43
    v_perm_b32 v42, v166, v162, s60
    v_perm_b32 v43, v166, v162, s61
    v_perm_b32 v162, v180, v176, s60
    v_perm_b32 v166, v180, v176, s61
    v_mov_b32 v176, v42
    v_mov_b32 v180, v43
    v_perm_b32 v42, v167, v163, s60
    v_perm_b32 v43, v167, v163, s61
    v_perm_b32 v163, v188, v184, s60
    v_perm_b32 v167, v188, v184, s61
    v_mov_b32 v184, v42
    v_mov_b32 v188, v43
    v_perm_b32 v42, v173, v169, s60
    v_perm_b32 v173, v173, v169, s61
    v_mov_b32 v169, v42
    v_perm_b32 v42, v174, v170, s60
    v_perm_b32 v43, v174, v170, s61
    v_perm_b32 v170, v181, v177, s60
    v_perm_b32 v174, v181, v177, s61
    v_mov_b32 v177, v42
    v_mov_b32 v181, v43
    v_perm_b32 v42, v175, v171, s60
    v_perm_b32 v43, v175, v171, s61
    v_perm_b32 v171, v189, v185, s60
    v_perm_b32 v175, v189, v185, s61
    v_mov_b32 v185, v42
    v_mov_b32 v189, v43
    v_perm_b32 v42, v182, v178, s60
    v_perm_b32 v182, v182, v178, s61
    v_mov_b32 v178, v42
    v_perm_b32 v42, v183, v179, s60
    v_perm_b32 v43, v183, v179, s61
    v_perm_b32 v179, v190, v186, s60
    v_perm_b32 v183, v190, v186, s61
    v_mov_b32 v186, v42
    v_mov_b32 v190, v43
    v_perm_b32 v42, v191, v187, s60
    v_perm_b32 v191, v191, v187, s61
    v_mov_b32 v187, v42
L_tr_doneH:
    s_cmp_lg_u32 s3, 4
    s_cbranch_scc1 L_loop_done
    v_and_b32 v42, 31, v3
    v_lshlrev_b32 v42, 4, v42
    v_add_u32 v42, 0x1000, v42
    s_mov_b32 s78, 0
L_poll_C:
    global_load_dwordx4 v[46:49], v42, s[38:39] sc1
    s_waitcnt vmcnt(0)
    v_perm_b32 v43, v47, v46, s66
    v_perm_b32 v44, v49, v48, s67
    v_or_b32 v43, v43, v44
    v_xor_b32 v2, v43, v58
    v_cmp_ne_u32 vcc, 0, v2
    s_cmp_eq_u64 vcc, 0
    s_cbranch_scc1 L_pollok_C
    s_add_u32 s78, s78, 1
    s_cmp_lt_u32 s78, 8192
    s_cbranch_scc1 L_poll_C
L_pollok_C:
    s_getreg_b32 s4, hwreg(HW_REG_XCC_ID)
    s_and_b32 s4, s4, 15
    v_lshrrev_b32 v46, 8, v46
    v_xor_b32 v46, s4, v46
    v_or_b32 v46, v46, v2
    v_cmp_ne_u32 vcc, 0, v46
    s_cmp_eq_u64 vcc, 0
    s_cselect_b32 s4, 1, 0
    v_mov_b32 v43, s4
    ds_write_b32 v62, v43 offset:516
    s_branch L_loop_done
L_help_plain:
    v_dot2_f32_bf16 v32, v128, v4, 0
    v_dot2_f32_bf16 v33, v132, v4, 0
    v_dot2_f32_bf16 v34, v136, v8, 0
    v_dot2_f32_bf16 v35, v140, v8, 0
    v_dot2_f32_bf16 v32, v129, v5, v32
    v_dot2_f32_bf16 v33, v133, v5, v33
    v_dot2_f32_bf16 v34, v137, v9, v34
    v_dot2_f32_bf16 v35, v141, v9, v35
    v_dot2_f32_bf16 v32, v130, v6, v32
    v_dot2_f32_bf16 v33, v134, v6, v33
    v_dot2_f32_bf16 v34, v138, v10, v34
    v_dot2_f32_bf16 v35, v142, v10, v35
    v_dot2_f32_bf16 v32, v131, v7, v32
    v_dot2_f32_bf16 v33, v135, v7, v33
    v_dot2_f32_bf16 v34, v139, v11, v34
    v_dot2_f32_bf16 v35, v143, v11, v35
    v_add_f32_dpp v32, v32, v32 row_ror:8 row_mask:0xf bank_mask:0xf
    v_add_f32_dpp v33, v33, v33 row_ror:8 row_mask:0xf bank_mask:0xf
    v_add_f32_dpp v34, v34, v34 row_ror:8 row_mask:0xf bank_mask:0xf
    v_add_f32_dpp v35, v35, v35 row_ror:8 row_mask:0xf bank_mask:0xf
    v_add_f32_dpp v32, v32, v32 row_ror:4 row_mask:0xf bank_mask:0xf
    v_add_f32_dpp v33, v33, v33 row_ror:4 row_mask:0xf bank_mask:0xf
    v_add_f32_dpp v34, v34, v34 row_ror:4 row_mask:0xf bank_mask:0xf
    v_add_f32_dpp v35, v35, v35 row_ror:4 row_mask:0xf bank_mask:0xf
    v_add_f32_dpp v32, v32, v32 row_ror:2 row_mask:0xf bank_mask:0xf
    v_add_f32_dpp v33, v33, v33 row_ror:2 row_mask:0xf bank_mask:0xf
    v_add_f32_dpp v34, v34, v34 row_ror:2 row_mask:0xf bank_mask:0xf
    v_add_f32_dpp v35, v35, v35 row_ror:2 row_mask:0xf bank_mask:0xf
    v_add_f32_dpp v32, v32, v32 row_ror:1 row_mask:0xf bank_mask:0xf
    v_add_f32_dpp v33, v33, v33 row_ror:1 row_mask:0xf bank_mask:0xf
    v_add_f32_dpp v34, v34, v34 row_ror:1 row_mask:0xf bank_mask:0xf
    v_add_f32_dpp v35, v35, v35 row_ror:1 row_mask:0xf bank_mask:0xf
    v_cvt_pk_bf16_f32 v42, v32, v33
    v_cvt_pk_bf16_f32 v43, v34, v35
    v_lshlrev_b32 v32, 16, v42
    v_and_b32 v33, 0xffff0000, v42
    v_lshlrev_b32 v34, 16, v43
    v_and_b32 v35, 0xffff0000, v43
    v_mul_f32 v32, s69, v32
    v_mul_f32 v33, s69, v33
    v_mul_f32 v34, s69, v34
    v_mul_f32 v35, s69, v35
    v_cvt_pk_bf16_f32 v42, v32, v33
    v_cvt_pk_bf16_f32 v43, v34, v35
    v_lshlrev_b32 v32, 16, v42
    v_and_b32 v33, 0xffff0000, v42
    v_lshlrev_b32 v34, 16, v43
    v_and_b32 v35, 0xffff0000, v43
    v_max3_f32 v46, v32, v33, v12
    v_max3_f32 v47, v34, v35, v14
    v_sub_f32 v48, v12, v46
    v_sub_f32 v49, v14, v47
    v_mul_f32 v40, s68, v46
    v_mul_f32 v41, s68, v47
    v_mul_f32 v48, s68, v48
    v_mul_f32 v49, s68, v49
    v_mov_b32 v12, v46
    v_mov_b32 v14, v47
    v_fma_f32 v32, v32, s68, -v40
    v_fma_f32 v33, v33, s68, -v40
    v_fma_f32 v34, v34, s68, -v41
    v_fma_f32 v35, v35, s68, -v41
    v_exp_f32 v38, v48
    v_exp_f32 v39, v49
    v_exp_f32 v32, v32
    v_exp_f32 v33, v33
    v_exp_f32 v34, v34
    v_exp_f32 v35, v35
    v_mul_f32 v16, v16, v38
    v_mul_f32 v17, v17, v38
    v_mul_f32 v18, v18, v38
    v_mul_f32 v19, v19, v38
    v_mul_f32 v20, v20, v38
    v_mul_f32 v21, v21, v38
    v_mul_f32 v22, v22, v38
    v_mul_f32 v23, v23, v38
    v_mul_f32 v24, v24, v39
    v_mul_f32 v25, v25, v39
    v_mul_f32 v26, v26, v39
    v_mul_f32 v27, v27, v39
    v_mul_f32 v28, v28, v39
    v_mul_f32 v29, v29, v39
    v_mul_f32 v30, v30, v39
    v_mul_f32 v31, v31, v39
    v_cvt_pk_bf16_f32 v36, v32, v33
    v_cvt_pk_bf16_f32 v37, v34, v35
    v_add_f32 v46, v32, v33
    v_add_f32 v47, v34, v35
    v_fma_f32 v13, v13, v38, v46
    v_fma_f32 v15, v15, v39, v47
    v_perm_b32 v42, v164, v160, s60
    v_perm_b32 v43, v164, v160, s61
    v_perm_b32 v44, v165, v161, s60
    v_perm_b32 v45, v165, v161, s61
    v_dot2_f32_bf16 v16, v42, v36, v16
    v_dot2_f32_bf16 v17, v43, v36, v17
    v_dot2_f32_bf16 v18, v44, v36, v18
    v_dot2_f32_bf16 v19, v45, v36, v19
    v_perm_b32 v42, v166, v162, s60
    v_perm_b32 v43, v166, v162, s61
    v_perm_b32 v44, v167, v163, s60
    v_perm_b32 v45, v167, v163, s61
    v_dot2_f32_bf16 v20, v42, v36, v20
    v_dot2_f32_bf16 v21, v43, v36, v21
    v_dot2_f32_bf16 v22, v44, v36, v22
    v_dot2_f32_bf16 v23, v45, v36, v23
    v_perm_b32 v46, v172, v168, s60
    v_perm_b32 v47, v172, v168, s61
    v_perm_b32 v48, v173, v169, s60
    v_perm_b32 v49, v173, v169, s61
    v_dot2_f32_bf16 v24, v46, v37, v24
    v_dot2_f32_bf16 v25, v47, v37, v25
    v_dot2_f32_bf16 v26, v48, v37, v26
    v_dot2_f32_bf16 v27, v49, v37, v27
    v_perm_b32 v46, v174, v170, s60
    v_perm_b32 v47, v174, v170, s61
    v_perm_b32 v48, v175, v171, s60
    v_perm_b32 v49, v175, v171, s61
    v_dot2_f32_bf16 v28, v46, v37, v28
    v_dot2_f32_bf16 v29, v47, v37, v29
    v_dot2_f32_bf16 v30, v48, v37, v30
    v_dot2_f32_bf16 v31, v49, v37, v31
    v_dot2_f32_bf16 v32, v144, v4, 0
    v_dot2_f32_bf16 v33, v148, v4, 0
    v_dot2_f32_bf16 v34, v152, v8, 0
    v_dot2_f32_bf16 v35, v156, v8, 0
    v_dot2_f32_bf16 v32, v145, v5, v32
    v_dot2_f32_bf16 v33, v149, v5, v33
    v_dot2_f32_bf16 v34, v153, v9, v34
    v_dot2_f32_bf16 v35, v157, v9, v35
    v_dot2_f32_bf16 v32, v146, v6, v32
    v_dot2_f32_bf16 v33, v150, v6, v33
    v_dot2_f32_bf16 v34, v154, v10, v34
    v_dot2_f32_bf16 v35, v158, v10, v35
    v_dot2_f32_bf16 v32, v147, v7, v32
    v_dot2_f32_bf16 v33, v151, v7, v33
    v_dot2_f32_bf16 v34, v155, v11, v34
    v_dot2_f32_bf16 v35, v159, v11, v35
    v_add_f32_dpp v32, v32, v32 row_ror:8 row_mask:0xf bank_mask:0xf
    v_add_f32_dpp v33, v33, v33 row_ror:8 row_mask:0xf bank_mask:0xf
    v_add_f32_dpp v34, v34, v34 row_ror:8 row_mask:0xf bank_mask:0xf
    v_add_f32_dpp v35, v35, v35 row_ror:8 row_mask:0xf bank_mask:0xf
    v_add_f32_dpp v32, v32, v32 row_ror:4 row_mask:0xf bank_mask:0xf
    v_add_f32_dpp v33, v33, v33 row_ror:4 row_mask:0xf bank_mask:0xf
    v_add_f32_dpp v34, v34, v34 row_ror:4 row_mask:0xf bank_mask:0xf
    v_add_f32_dpp v35, v35, v35 row_ror:4 row_mask:0xf bank_mask:0xf
    v_add_f32_dpp v32, v32, v32 row_ror:2 row_mask:0xf bank_mask:0xf
    v_add_f32_dpp v33, v33, v33 row_ror:2 row_mask:0xf bank_mask:0xf
    v_add_f32_dpp v34, v34, v34 row_ror:2 row_mask:0xf bank_mask:0xf
    v_add_f32_dpp v35, v35, v35 row_ror:2 row_mask:0xf bank_mask:0xf
    v_add_f32_dpp v32, v32, v32 row_ror:1 row_mask:0xf bank_mask:0xf
    v_add_f32_dpp v33, v33, v33 row_ror:1 row_mask:0xf bank_mask:0xf
    v_add_f32_dpp v34, v34, v34 row_ror:1 row_mask:0xf bank_mask:0xf
    v_add_f32_dpp v35, v35, v35 row_ror:1 row_mask:0xf bank_mask:0xf
    v_cvt_pk_bf16_f32 v42, v32, v33
    v_cvt_pk_bf16_f32 v43, v34, v35
    v_lshlrev_b32 v32, 16, v42
    v_and_b32 v33, 0xffff0000, v42
    v_lshlrev_b32 v34, 16, v43
    v_and_b32 v35, 0xffff0000, v43
    v_mul_f32 v32, s69, v32
    v_mul_f32 v33, s69, v33
    v_mul_f32 v34, s69, v34
    v_mul_f32 v35, s69, v35
    v_cvt_pk_bf16_f32 v42, v32, v33
    v_cvt_pk_bf16_f32 v43, v34, v35
    v_lshlrev_b32 v32, 16, v42
    v_and_b32 v33, 0xffff0000, v42
    v_lshlrev_b32 v34, 16, v43
    v_and_b32 v35, 0xffff0000, v43
    v_max3_f32 v46, v32, v33, v12
    v_max3_f32 v47, v34, v35, v14
    v_sub_f32 v48, v12, v46
    v_sub_f32 v49, v14, v47
    v_mul_f32 v40, s68, v46
    v_mul_f32 v41, s68, v47
    v_mul_f32 v48, s68, v48
    v_mul_f32 v49, s68, v49
    v_mov_b32 v12, v46
    v_mov_b32 v14, v47
    v_fma_f32 v32, v32, s68, -v40
    v_fma_f32 v33, v33, s68, -v40
    v_fma_f32 v34, v34, s68, -v41
    v_fma_f32 v35, v35, s68, -v41
    v_exp_f32 v38, v48
    v_exp_f32 v39, v49
    v_exp_f32 v32, v32
    v_exp_f32 v33, v33
    v_exp_f32 v34, v34
    v_exp_f32 v35, v35
    v_mul_f32 v16, v16, v38
    v_mul_f32 v17, v17, v38
    v_mul_f32 v18, v18, v38
    v_mul_f32 v19, v19, v38
    v_mul_f32 v20, v20, v38
    v_mul_f32 v21, v21, v38
    v_mul_f32 v22, v22, v38
    v_mul_f32 v23, v23, v38
    v_mul_f32 v24, v24, v39
    v_mul_f32 v25, v25, v39
    v_mul_f32 v26, v26, v39
    v_mul_f32 v27, v27, v39
    v_mul_f32 v28, v28, v39
    v_mul_f32 v29, v29, v39
    v_mul_f32 v30, v30, v39
    v_mul_f32 v31, v31, v39
    v_cvt_pk_bf16_f32 v36, v32, v33
    v_cvt_pk_bf16_f32 v37, v34, v35
    v_add_f32 v46, v32, v33
    v_add_f32 v47, v34, v35
    v_fma_f32 v13, v13, v38, v46
    v_fma_f32 v15, v15, v39, v47
    v_perm_b32 v42, v180, v176, s60
    v_perm_b32 v43, v180, v176, s61
    v_perm_b32 v44, v181, v177, s60
    v_perm_b32 v45, v181, v177, s61
    v_dot2_f32_bf16 v16, v42, v36, v16
    v_dot2_f32_bf16 v17, v43, v36, v17
    v_dot2_f32_bf16 v18, v44, v36, v18
    v_dot2_f32_bf16 v19, v45, v36, v19
    v_perm_b32 v42, v182, v178, s60
    v_perm_b32 v43, v182, v178, s61
    v_perm_b32 v44, v183, v179, s60
    v_perm_b32 v45, v183, v179, s61
    v_dot2_f32_bf16 v20, v42, v36, v20
    v_dot2_f32_bf16 v21, v43, v36, v21
    v_dot2_f32_bf16 v22, v44, v36, v22
    v_dot2_f32_bf16 v23, v45, v36, v23
    v_perm_b32 v46, v188, v184, s60
    v_perm_b32 v47, v188, v184, s61
    v_perm_b32 v48, v189, v185, s60
    v_perm_b32 v49, v189, v185, s61
    v_dot2_f32_bf16 v24, v46, v37, v24
    v_dot2_f32_bf16 v25, v47, v37, v25
    v_dot2_f32_bf16 v26, v48, v37, v26
    v_dot2_f32_bf16 v27, v49, v37, v27
    v_perm_b32 v46, v190, v186, s60
    v_perm_b32 v47, v190, v186, s61
    v_perm_b32 v48, v191, v187, s60
    v_perm_b32 v49, v191, v187, s61
    v_dot2_f32_bf16 v28, v46, v37, v28
    v_dot2_f32_bf16 v29, v47, v37, v29
    v_dot2_f32_bf16 v30, v48, v37, v30
    v_dot2_f32_bf16 v31, v49, v37, v31
    v_dot2_f32_bf16 v32, v192, v4, 0
    v_dot2_f32_bf16 v33, v196, v4, 0
    v_dot2_f32_bf16 v34, v200, v8, 0
    v_dot2_f32_bf16 v35, v204, v8, 0
    v_dot2_f32_bf16 v32, v193, v5, v32
    v_dot2_f32_bf16 v33, v197, v5, v33
    v_dot2_f32_bf16 v34, v201, v9, v34
    v_dot2_f32_bf16 v35, v205, v9, v35
    v_dot2_f32_bf16 v32, v194, v6, v32
    v_dot2_f32_bf16 v33, v198, v6, v33
    v_dot2_f32_bf16 v34, v202, v10, v34
    v_dot2_f32_bf16 v35, v206, v10, v35
    v_dot2_f32_bf16 v32, v195, v7, v32
    v_dot2_f32_bf16 v33, v199, v7, v33
    v_dot2_f32_bf16 v34, v203, v11, v34
    v_dot2_f32_bf16 v35, v207, v11, v35
    v_add_f32_dpp v32, v32, v32 row_ror:8 row_mask:0xf bank_mask:0xf
    v_add_f32_dpp v33, v33, v33 row_ror:8 row_mask:0xf bank_mask:0xf
    v_add_f32_dpp v34, v34, v34 row_ror:8 row_mask:0xf bank_mask:0xf
    v_add_f32_dpp v35, v35, v35 row_ror:8 row_mask:0xf bank_mask:0xf
    v_add_f32_dpp v32, v32, v32 row_ror:4 row_mask:0xf bank_mask:0xf
    v_add_f32_dpp v33, v33, v33 row_ror:4 row_mask:0xf bank_mask:0xf
    v_add_f32_dpp v34, v34, v34 row_ror:4 row_mask:0xf bank_mask:0xf
    v_add_f32_dpp v35, v35, v35 row_ror:4 row_mask:0xf bank_mask:0xf
    v_add_f32_dpp v32, v32, v32 row_ror:2 row_mask:0xf bank_mask:0xf
    v_add_f32_dpp v33, v33, v33 row_ror:2 row_mask:0xf bank_mask:0xf
    v_add_f32_dpp v34, v34, v34 row_ror:2 row_mask:0xf bank_mask:0xf
    v_add_f32_dpp v35, v35, v35 row_ror:2 row_mask:0xf bank_mask:0xf
    v_add_f32_dpp v32, v32, v32 row_ror:1 row_mask:0xf bank_mask:0xf
    v_add_f32_dpp v33, v33, v33 row_ror:1 row_mask:0xf bank_mask:0xf
    v_add_f32_dpp v34, v34, v34 row_ror:1 row_mask:0xf bank_mask:0xf
    v_add_f32_dpp v35, v35, v35 row_ror:1 row_mask:0xf bank_mask:0xf
    v_cvt_pk_bf16_f32 v42, v32, v33
    v_cvt_pk_bf16_f32 v43, v34, v35
    v_lshlrev_b32 v32, 16, v42
    v_and_b32 v33, 0xffff0000, v42
    v_lshlrev_b32 v34, 16, v43
    v_and_b32 v35, 0xffff0000, v43
    v_mul_f32 v32, s69, v32
    v_mul_f32 v33, s69, v33
    v_mul_f32 v34, s69, v34
    v_mul_f32 v35, s69, v35
    v_cvt_pk_bf16_f32 v42, v32, v33
    v_cvt_pk_bf16_f32 v43, v34, v35
    v_lshlrev_b32 v32, 16, v42
    v_and_b32 v33, 0xffff0000, v42
    v_lshlrev_b32 v34, 16, v43
    v_and_b32 v35, 0xffff0000, v43
    v_max3_f32 v46, v32, v33, v12
    v_max3_f32 v47, v34, v35, v14
    v_sub_f32 v48, v12, v46
    v_sub_f32 v49, v14, v47
    v_mul_f32 v40, s68, v46
    v_mul_f32 v41, s68, v47
    v_mul_f32 v48, s68, v48
    v_mul_f32 v49, s68, v49
    v_mov_b32 v12, v46
    v_mov_b32 v14, v47
    v_fma_f32 v32, v32, s68, -v40
    v_fma_f32 v33, v33, s68, -v40
    v_fma_f32 v34, v34, s68, -v41
    v_fma_f32 v35, v35, s68, -v41
    v_exp_f32 v38, v48
    v_exp_f32 v39, v49
    v_exp_f32 v32, v32
    v_exp_f32 v33, v33
    v_exp_f32 v34, v34
    v_exp_f32 v35, v35
    v_mul_f32 v16, v16, v38
    v_mul_f32 v17, v17, v38
    v_mul_f32 v18, v18, v38
    v_mul_f32 v19, v19, v38
    v_mul_f32 v20, v20, v38
    v_mul_f32 v21, v21, v38
    v_mul_f32 v22, v22, v38
    v_mul_f32 v23, v23, v38
    v_mul_f32 v24, v24, v39
    v_mul_f32 v25, v25, v39
    v_mul_f32 v26, v26, v39
    v_mul_f32 v27, v27, v39
    v_mul_f32 v28, v28, v39
    v_mul_f32 v29, v29, v39
    v_mul_f32 v30, v30, v39
    v_mul_f32 v31, v31, v39
    v_cvt_pk_bf16_f32 v36, v32, v33
    v_cvt_pk_bf16_f32 v37, v34, v35
    v_add_f32 v46, v32, v33
    v_add_f32 v47, v34, v35
    v_fma_f32 v13, v13, v38, v46
    v_fma_f32 v15, v15, v39, v47
    v_perm_b32 v42, v228, v224, s60
    v_perm_b32 v43, v228, v224, s61
    v_perm_b32 v44, v229, v225, s60
    v_perm_b32 v45, v229, v225, s61
    v_dot2_f32_bf16 v16, v42, v36, v16
    v_dot2_f32_bf16 v17, v43, v36, v17
    v_dot2_f32_bf16 v18, v44, v36, v18
    v_dot2_f32_bf16 v19, v45, v36, v19
    v_perm_b32 v42, v230, v226, s60
    v_perm_b32 v43, v230, v226, s61
    v_perm_b32 v44, v231, v227, s60
    v_perm_b32 v45, v231, v227, s61
    v_dot2_f32_bf16 v20, v42, v36, v20
    v_dot2_f32_bf16 v21, v43, v36, v21
    v_dot2_f32_bf16 v22, v44, v36, v22
    v_dot2_f32_bf16 v23, v45, v36, v23
    v_perm_b32 v46, v236, v232, s60
    v_perm_b32 v47, v236, v232, s61
    v_perm_b32 v48, v237, v233, s60
    v_perm_b32 v49, v237, v233, s61
    v_dot2_f32_bf16 v24, v46, v37, v24
    v_dot2_f32_bf16 v25, v47, v37, v25
    v_dot2_f32_bf16 v26, v48, v37, v26
    v_dot2_f32_bf16 v27, v49, v37, v27
    v_perm_b32 v46, v238, v234, s60
    v_perm_b32 v47, v238, v234, s61
    v_perm_b32 v48, v239, v235, s60
    v_perm_b32 v49, v239, v235, s61
    v_dot2_f32_bf16 v28, v46, v37, v28
    v_dot2_f32_bf16 v29, v47, v37, v29
    v_dot2_f32_bf16 v30, v48, v37, v30
    v_dot2_f32_bf16 v31, v49, v37, v31
    v_dot2_f32_bf16 v32, v208, v4, 0
    v_dot2_f32_bf16 v33, v212, v4, 0
    v_dot2_f32_bf16 v34, v216, v8, 0
    v_dot2_f32_bf16 v35, v220, v8, 0
    v_dot2_f32_bf16 v32, v209, v5, v32
    v_dot2_f32_bf16 v33, v213, v5, v33
    v_dot2_f32_bf16 v34, v217, v9, v34
    v_dot2_f32_bf16 v35, v221, v9, v35
    v_dot2_f32_bf16 v32, v210, v6, v32
    v_dot2_f32_bf16 v33, v214, v6, v33
    v_dot2_f32_bf16 v34, v218, v10, v34
    v_dot2_f32_bf16 v35, v222, v10, v35
    v_dot2_f32_bf16 v32, v211, v7, v32
    v_dot2_f32_bf16 v33, v215, v7, v33
    v_dot2_f32_bf16 v34, v219, v11, v34
    v_dot2_f32_bf16 v35, v223, v11, v35
    v_add_f32_dpp v32, v32, v32 row_ror:8 row_mask:0xf bank_mask:0xf
    v_add_f32_dpp v33, v33, v33 row_ror:8 row_mask:0xf bank_mask:0xf
    v_add_f32_dpp v34, v34, v34 row_ror:8 row_mask:0xf bank_mask:0xf
    v_add_f32_dpp v35, v35, v35 row_ror:8 row_mask:0xf bank_mask:0xf
    v_add_f32_dpp v32, v32, v32 row_ror:4 row_mask:0xf bank_mask:0xf
    v_add_f32_dpp v33, v33, v33 row_ror:4 row_mask:0xf bank_mask:0xf
    v_add_f32_dpp v34, v34, v34 row_ror:4 row_mask:0xf bank_mask:0xf
    v_add_f32_dpp v35, v35, v35 row_ror:4 row_mask:0xf bank_mask:0xf
    v_add_f32_dpp v32, v32, v32 row_ror:2 row_mask:0xf bank_mask:0xf
    v_add_f32_dpp v33, v33, v33 row_ror:2 row_mask:0xf bank_mask:0xf
    v_add_f32_dpp v34, v34, v34 row_ror:2 row_mask:0xf bank_mask:0xf
    v_add_f32_dpp v35, v35, v35 row_ror:2 row_mask:0xf bank_mask:0xf
    v_add_f32_dpp v32, v32, v32 row_ror:1 row_mask:0xf bank_mask:0xf
    v_add_f32_dpp v33, v33, v33 row_ror:1 row_mask:0xf bank_mask:0xf
    v_add_f32_dpp v34, v34, v34 row_ror:1 row_mask:0xf bank_mask:0xf
    v_add_f32_dpp v35, v35, v35 row_ror:1 row_mask:0xf bank_mask:0xf
    v_cvt_pk_bf16_f32 v42, v32, v33
    v_cvt_pk_bf16_f32 v43, v34, v35
    v_lshlrev_b32 v32, 16, v42
    v_and_b32 v33, 0xffff0000, v42
    v_lshlrev_b32 v34, 16, v43
    v_and_b32 v35, 0xffff0000, v43
    v_mul_f32 v32, s69, v32
    v_mul_f32 v33, s69, v33
    v_mul_f32 v34, s69, v34
    v_mul_f32 v35, s69, v35
    v_cvt_pk_bf16_f32 v42, v32, v33
    v_cvt_pk_bf16_f32 v43, v34, v35
    v_lshlrev_b32 v32, 16, v42
    v_and_b32 v33, 0xffff0000, v42
    v_lshlrev_b32 v34, 16, v43
    v_and_b32 v35, 0xffff0000, v43
    v_max3_f32 v46, v32, v33, v12
    v_max3_f32 v47, v34, v35, v14
    v_sub_f32 v48, v12, v46
    v_sub_f32 v49, v14, v47
    v_mul_f32 v40, s68, v46
    v_mul_f32 v41, s68, v47
    v_mul_f32 v48, s68, v48
    v_mul_f32 v49, s68, v49
    v_mov_b32 v12, v46
    v_mov_b32 v14, v47
    v_fma_f32 v32, v32, s68, -v40
    v_fma_f32 v33, v33, s68, -v40
    v_fma_f32 v34, v34, s68, -v41
    v_fma_f32 v35, v35, s68, -v41
    v_exp_f32 v38, v48
    v_exp_f32 v39, v49
    v_exp_f32 v32, v32
    v_exp_f32 v33, v33
    v_exp_f32 v34, v34
    v_exp_f32 v35, v35
    v_mul_f32 v16, v16, v38
    v_mul_f32 v17, v17, v38
    v_mul_f32 v18, v18, v38
    v_mul_f32 v19, v19, v38
    v_mul_f32 v20, v20, v38
    v_mul_f32 v21, v21, v38
    v_mul_f32 v22, v22, v38
    v_mul_f32 v23, v23, v38
    v_mul_f32 v24, v24, v39
    v_mul_f32 v25, v25, v39
    v_mul_f32 v26, v26, v39
    v_mul_f32 v27, v27, v39
    v_mul_f32 v28, v28, v39
    v_mul_f32 v29, v29, v39
    v_mul_f32 v30, v30, v39
    v_mul_f32 v31, v31, v39
    v_cvt_pk_bf16_f32 v36, v32, v33
    v_cvt_pk_bf16_f32 v37, v34, v35
    v_add_f32 v46, v32, v33
    v_add_f32 v47, v34, v35
    v_fma_f32 v13, v13, v38, v46
    v_fma_f32 v15, v15, v39, v47
    v_perm_b32 v42, v244, v240, s60
    v_perm_b32 v43, v244, v240, s61
    v_perm_b32 v44, v245, v241, s60
    v_perm_b32 v45, v245, v241, s61
    v_dot2_f32_bf16 v16, v42, v36, v16
    v_dot2_f32_bf16 v17, v43, v36, v17
    v_dot2_f32_bf16 v18, v44, v36, v18
    v_dot2_f32_bf16 v19, v45, v36, v19
    v_perm_b32 v42, v246, v242, s60
    v_perm_b32 v43, v246, v242, s61
    v_perm_b32 v44, v247, v243, s60
    v_perm_b32 v45, v247, v243, s61
    v_dot2_f32_bf16 v20, v42, v36, v20
    v_dot2_f32_bf16 v21, v43, v36, v21
    v_dot2_f32_bf16 v22, v44, v36, v22
    v_dot2_f32_bf16 v23, v45, v36, v23
    v_perm_b32 v46, v252, v248, s60
    v_perm_b32 v47, v252, v248, s61
    v_perm_b32 v48, v253, v249, s60
    v_perm_b32 v49, v253, v249, s61
    v_dot2_f32_bf16 v24, v46, v37, v24
    v_dot2_f32_bf16 v25, v47, v37, v25
    v_dot2_f32_bf16 v26, v48, v37, v26
    v_dot2_f32_bf16 v27, v49, v37, v27
    v_perm_b32 v46, v254, v250, s60
    v_perm_b32 v47, v254, v250, s61
    v_perm_b32 v48, v255, v251, s60
    v_perm_b32 v49, v255, v251, s61
    v_dot2_f32_bf16 v28, v46, v37, v28
    v_dot2_f32_bf16 v29, v47, v37, v29
    v_dot2_f32_bf16 v30, v48, v37, v30
    v_dot2_f32_bf16 v31, v49, v37, v31
    v_dot2_f32_bf16 v32, v64, v4, 0
    v_dot2_f32_bf16 v33, v68, v4, 0
    v_dot2_f32_bf16 v34, v72, v8, 0
    v_dot2_f32_bf16 v35, v76, v8, 0
    v_dot2_f32_bf16 v32, v65, v5, v32
    v_dot2_f32_bf16 v33, v69, v5, v33
    v_dot2_f32_bf16 v34, v73, v9, v34
    v_dot2_f32_bf16 v35, v77, v9, v35
    v_dot2_f32_bf16 v32, v66, v6, v32
    v_dot2_f32_bf16 v33, v70, v6, v33
    v_dot2_f32_bf16 v34, v74, v10, v34
    v_dot2_f32_bf16 v35, v78, v10, v35
    v_dot2_f32_bf16 v32, v67, v7, v32
    v_dot2_f32_bf16 v33, v71, v7, v33
    v_dot2_f32_bf16 v34, v75, v11, v34
    v_dot2_f32_bf16 v35, v79, v11, v35
    v_add_f32_dpp v32, v32, v32 row_ror:8 row_mask:0xf bank_mask:0xf
    v_add_f32_dpp v33, v33, v33 row_ror:8 row_mask:0xf bank_mask:0xf
    v_add_f32_dpp v34, v34, v34 row_ror:8 row_mask:0xf bank_mask:0xf
    v_add_f32_dpp v35, v35, v35 row_ror:8 row_mask:0xf bank_mask:0xf
    v_add_f32_dpp v32, v32, v32 row_ror:4 row_mask:0xf bank_mask:0xf
    v_add_f32_dpp v33, v33, v33 row_ror:4 row_mask:0xf bank_mask:0xf
    v_add_f32_dpp v34, v34, v34 row_ror:4 row_mask:0xf bank_mask:0xf
    v_add_f32_dpp v35, v35, v35 row_ror:4 row_mask:0xf bank_mask:0xf
    v_add_f32_dpp v32, v32, v32 row_ror:2 row_mask:0xf bank_mask:0xf
    v_add_f32_dpp v33, v33, v33 row_ror:2 row_mask:0xf bank_mask:0xf
    v_add_f32_dpp v34, v34, v34 row_ror:2 row_mask:0xf bank_mask:0xf
    v_add_f32_dpp v35, v35, v35 row_ror:2 row_mask:0xf bank_mask:0xf
    v_add_f32_dpp v32, v32, v32 row_ror:1 row_mask:0xf bank_mask:0xf
    v_add_f32_dpp v33, v33, v33 row_ror:1 row_mask:0xf bank_mask:0xf
    v_add_f32_dpp v34, v34, v34 row_ror:1 row_mask:0xf bank_mask:0xf
    v_add_f32_dpp v35, v35, v35 row_ror:1 row_mask:0xf bank_mask:0xf
    v_cvt_pk_bf16_f32 v42, v32, v33
    v_cvt_pk_bf16_f32 v43, v34, v35
    v_lshlrev_b32 v32, 16, v42
    v_and_b32 v33, 0xffff0000, v42
    v_lshlrev_b32 v34, 16, v43
    v_and_b32 v35, 0xffff0000, v43
    v_mul_f32 v32, s69, v32
    v_mul_f32 v33, s69, v33
    v_mul_f32 v34, s69, v34
    v_mul_f32 v35, s69, v35
    v_cvt_pk_bf16_f32 v42, v32, v33
    v_cvt_pk_bf16_f32 v43, v34, v35
    v_lshlrev_b32 v32, 16, v42
    v_and_b32 v33, 0xffff0000, v42
    v_lshlrev_b32 v34, 16, v43
    v_and_b32 v35, 0xffff0000, v43
    v_max3_f32 v46, v32, v33, v12
    v_max3_f32 v47, v34, v35, v14
    v_sub_f32 v48, v12, v46
    v_sub_f32 v49, v14, v47
    v_mul_f32 v40, s68, v46
    v_mul_f32 v41, s68, v47
    v_mul_f32 v48, s68, v48
    v_mul_f32 v49, s68, v49
    v_mov_b32 v12, v46
    v_mov_b32 v14, v47
    v_fma_f32 v32, v32, s68, -v40
    v_fma_f32 v33, v33, s68, -v40
    v_fma_f32 v34, v34, s68, -v41
    v_fma_f32 v35, v35, s68, -v41
    v_exp_f32 v38, v48
    v_exp_f32 v39, v49
    v_exp_f32 v32, v32
    v_exp_f32 v33, v33
    v_exp_f32 v34, v34
    v_exp_f32 v35, v35
    v_mul_f32 v16, v16, v38
    v_mul_f32 v17, v17, v38
    v_mul_f32 v18, v18, v38
    v_mul_f32 v19, v19, v38
    v_mul_f32 v20, v20, v38
    v_mul_f32 v21, v21, v38
    v_mul_f32 v22, v22, v38
    v_mul_f32 v23, v23, v38
    v_mul_f32 v24, v24, v39
    v_mul_f32 v25, v25, v39
    v_mul_f32 v26, v26, v39
    v_mul_f32 v27, v27, v39
    v_mul_f32 v28, v28, v39
    v_mul_f32 v29, v29, v39
    v_mul_f32 v30, v30, v39
    v_mul_f32 v31, v31, v39
    v_cvt_pk_bf16_f32 v36, v32, v33
    v_cvt_pk_bf16_f32 v37, v34, v35
    v_add_f32 v46, v32, v33
    v_add_f32 v47, v34, v35
    v_fma_f32 v13, v13, v38, v46
    v_fma_f32 v15, v15, v39, v47
    v_perm_b32 v42, v100, v96, s60
    v_perm_b32 v43, v100, v96, s61
    v_perm_b32 v44, v101, v97, s60
    v_perm_b32 v45, v101, v97, s61
    v_dot2_f32_bf16 v16, v42, v36, v16
    v_dot2_f32_bf16 v17, v43, v36, v17
    v_dot2_f32_bf16 v18, v44, v36, v18
    v_dot2_f32_bf16 v19, v45, v36, v19
    v_perm_b32 v42, v102, v98, s60
    v_perm_b32 v43, v102, v98, s61
    v_perm_b32 v44, v103, v99, s60
    v_perm_b32 v45, v103, v99, s61
    v_dot2_f32_bf16 v20, v42, v36, v20
    v_dot2_f32_bf16 v21, v43, v36, v21
    v_dot2_f32_bf16 v22, v44, v36, v22
    v_dot2_f32_bf16 v23, v45, v36, v23
    v_perm_b32 v46, v108, v104, s60
    v_perm_b32 v47, v108, v104, s61
    v_perm_b32 v48, v109, v105, s60
    v_perm_b32 v49, v109, v105, s61
    v_dot2_f32_bf16 v24, v46, v37, v24
    v_dot2_f32_bf16 v25, v47, v37, v25
    v_dot2_f32_bf16 v26, v48, v37, v26
    v_dot2_f32_bf16 v27, v49, v37, v27
    v_perm_b32 v46, v110, v106, s60
    v_perm_b32 v47, v110, v106, s61
    v_perm_b32 v48, v111, v107, s60
    v_perm_b32 v49, v111, v107, s61
    v_dot2_f32_bf16 v28, v46, v37, v28
    v_dot2_f32_bf16 v29, v47, v37, v29
    v_dot2_f32_bf16 v30, v48, v37, v30
    v_dot2_f32_bf16 v31, v49, v37, v31
    v_dot2_f32_bf16 v32, v80, v4, 0
    v_dot2_f32_bf16 v33, v84, v4, 0
    v_dot2_f32_bf16 v34, v88, v8, 0
    v_dot2_f32_bf16 v35, v92, v8, 0
    v_dot2_f32_bf16 v32, v81, v5, v32
    v_dot2_f32_bf16 v33, v85, v5, v33
    v_dot2_f32_bf16 v34, v89, v9, v34
    v_dot2_f32_bf16 v35, v93, v9, v35
    v_dot2_f32_bf16 v32, v82, v6, v32
    v_dot2_f32_bf16 v33, v86, v6, v33
    v_dot2_f32_bf16 v34, v90, v10, v34
    v_dot2_f32_bf16 v35, v94, v10, v35
    v_dot2_f32_bf16 v32, v83, v7, v32
    v_dot2_f32_bf16 v33, v87, v7, v33
    v_dot2_f32_bf16 v34, v91, v11, v34
    v_dot2_f32_bf16 v35, v95, v11, v35
    v_add_f32_dpp v32, v32, v32 row_ror:8 row_mask:0xf bank_mask:0xf
    v_add_f32_dpp v33, v33, v33 row_ror:8 row_mask:0xf bank_mask:0xf
    v_add_f32_dpp v34, v34, v34 row_ror:8 row_mask:0xf bank_mask:0xf
    v_add_f32_dpp v35, v35, v35 row_ror:8 row_mask:0xf bank_mask:0xf
    v_add_f32_dpp v32, v32, v32 row_ror:4 row_mask:0xf bank_mask:0xf
    v_add_f32_dpp v33, v33, v33 row_ror:4 row_mask:0xf bank_mask:0xf
    v_add_f32_dpp v34, v34, v34 row_ror:4 row_mask:0xf bank_mask:0xf
    v_add_f32_dpp v35, v35, v35 row_ror:4 row_mask:0xf bank_mask:0xf
    v_add_f32_dpp v32, v32, v32 row_ror:2 row_mask:0xf bank_mask:0xf
    v_add_f32_dpp v33, v33, v33 row_ror:2 row_mask:0xf bank_mask:0xf
    v_add_f32_dpp v34, v34, v34 row_ror:2 row_mask:0xf bank_mask:0xf
    v_add_f32_dpp v35, v35, v35 row_ror:2 row_mask:0xf bank_mask:0xf
    v_add_f32_dpp v32, v32, v32 row_ror:1 row_mask:0xf bank_mask:0xf
    v_add_f32_dpp v33, v33, v33 row_ror:1 row_mask:0xf bank_mask:0xf
    v_add_f32_dpp v34, v34, v34 row_ror:1 row_mask:0xf bank_mask:0xf
    v_add_f32_dpp v35, v35, v35 row_ror:1 row_mask:0xf bank_mask:0xf
    v_cvt_pk_bf16_f32 v42, v32, v33
    v_cvt_pk_bf16_f32 v43, v34, v35
    v_lshlrev_b32 v32, 16, v42
    v_and_b32 v33, 0xffff0000, v42
    v_lshlrev_b32 v34, 16, v43
    v_and_b32 v35, 0xffff0000, v43
    v_mul_f32 v32, s69, v32
    v_mul_f32 v33, s69, v33
    v_mul_f32 v34, s69, v34
    v_mul_f32 v35, s69, v35
    v_cvt_pk_bf16_f32 v42, v32, v33
    v_cvt_pk_bf16_f32 v43, v34, v35
    v_lshlrev_b32 v32, 16, v42
    v_and_b32 v33, 0xffff0000, v42
    v_lshlrev_b32 v34, 16, v43
    v_and_b32 v35, 0xffff0000, v43
    v_max3_f32 v46, v32, v33, v12
    v_max3_f32 v47, v34, v35, v14
    v_sub_f32 v48, v12, v46
    v_sub_f32 v49, v14, v47
    v_mul_f32 v40, s68, v46
    v_mul_f32 v41, s68, v47
    v_mul_f32 v48, s68, v48
    v_mul_f32 v49, s68, v49
    v_mov_b32 v12, v46
    v_mov_b32 v14, v47
    v_fma_f32 v32, v32, s68, -v40
    v_fma_f32 v33, v33, s68, -v40
    v_fma_f32 v34, v34, s68, -v41
    v_fma_f32 v35, v35, s68, -v41
    v_exp_f32 v38, v48
    v_exp_f32 v39, v49
    v_exp_f32 v32, v32
    v_exp_f32 v33, v33
    v_exp_f32 v34, v34
    v_exp_f32 v35, v35
    v_mul_f32 v16, v16, v38
    v_mul_f32 v17, v17, v38
    v_mul_f32 v18, v18, v38
    v_mul_f32 v19, v19, v38
    v_mul_f32 v20, v20, v38
    v_mul_f32 v21, v21, v38
    v_mul_f32 v22, v22, v38
    v_mul_f32 v23, v23, v38
    v_mul_f32 v24, v24, v39
    v_mul_f32 v25, v25, v39
    v_mul_f32 v26, v26, v39
    v_mul_f32 v27, v27, v39
    v_mul_f32 v28, v28, v39
    v_mul_f32 v29, v29, v39
    v_mul_f32 v30, v30, v39
    v_mul_f32 v31, v31, v39
    v_cvt_pk_bf16_f32 v36, v32, v33
    v_cvt_pk_bf16_f32 v37, v34, v35
    v_add_f32 v46, v32, v33
    v_add_f32 v47, v34, v35
    v_fma_f32 v13, v13, v38, v46
    v_fma_f32 v15, v15, v39, v47
    v_perm_b32 v42, v116, v112, s60
    v_perm_b32 v43, v116, v112, s61
    v_perm_b32 v44, v117, v113, s60
    v_perm_b32 v45, v117, v113, s61
    v_dot2_f32_bf16 v16, v42, v36, v16
    v_dot2_f32_bf16 v17, v43, v36, v17
    v_dot2_f32_bf16 v18, v44, v36, v18
    v_dot2_f32_bf16 v19, v45, v36, v19
    v_perm_b32 v42, v118, v114, s60
    v_perm_b32 v43, v118, v114, s61
    v_perm_b32 v44, v119, v115, s60
    v_perm_b32 v45, v119, v115, s61
    v_dot2_f32_bf16 v20, v42, v36, v20
    v_dot2_f32_bf16 v21, v43, v36, v21
    v_dot2_f32_bf16 v22, v44, v36, v22
    v_dot2_f32_bf16 v23, v45, v36, v23
    v_perm_b32 v46, v124, v120, s60
    v_perm_b32 v47, v124, v120, s61
    v_perm_b32 v48, v125, v121, s60
    v_perm_b32 v49, v125, v121, s61
    v_dot2_f32_bf16 v24, v46, v37, v24
    v_dot2_f32_bf16 v25, v47, v37, v25
    v_dot2_f32_bf16 v26, v48, v37, v26
    v_dot2_f32_bf16 v27, v49, v37, v27
    v_perm_b32 v46, v126, v122, s60
    v_perm_b32 v47, v126, v122, s61
    v_perm_b32 v48, v127, v123, s60
    v_perm_b32 v49, v127, v123, s61
    v_dot2_f32_bf16 v28, v46, v37, v28
    v_dot2_f32_bf16 v29, v47, v37, v29
    v_dot2_f32_bf16 v30, v48, v37, v30
    v_dot2_f32_bf16 v31, v49, v37, v31
    s_branch L_loop_done
L_stream:
    s_mov_b32 s97, 0
    s_mov_b32 s99, 0
    s_mov_b64 exec, 1
    ds_add_rtn_u32 v59, v62, v57 offset:512
    s_mov_b64 exec, -1
    s_waitcnt lgkmcnt(0)
    v_readfirstlane_b32 s4, v59
    s_add_u32 s4, s4, s98
    s_nop 0
    v_mov_b32 v60, s4
    s_mov_b64 exec, 1
    ds_add_rtn_u32 v59, v62, v57 offset:512
    s_mov_b64 exec, -1
    s_waitcnt lgkmcnt(0)
    v_readfirstlane_b32 s4, v59
    s_add_u32 s4, s4, s98
    s_nop 0
    v_mov_b32 v61, s4
    s_mov_b64 exec, 1
    ds_add_rtn_u32 v59, v62, v57 offset:512
    s_mov_b64 exec, -1
L_loop:
    s_waitcnt vmcnt(12)
    v_dot2_f32_bf16 v32, v128, v4, 0
    v_dot2_f32_bf16 v33, v132, v4, 0
    v_dot2_f32_bf16 v34, v136, v8, 0
    v_dot2_f32_bf16 v35, v140, v8, 0
    v_dot2_f32_bf16 v32, v129, v5, v32
    v_dot2_f32_bf16 v33, v133, v5, v33
    v_dot2_f32_bf16 v34, v137, v9, v34
    v_dot2_f32_bf16 v35, v141, v9, v35
    v_dot2_f32_bf16 v32, v130, v6, v32
    v_dot2_f32_bf16 v33, v134, v6, v33
    v_dot2_f32_bf16 v34, v138, v10, v34
    v_dot2_f32_bf16 v35, v142, v10, v35
    v_dot2_f32_bf16 v32, v131, v7, v32
    v_dot2_f32_bf16 v33, v135, v7, v33
    v_dot2_f32_bf16 v34, v139, v11, v34
    v_dot2_f32_bf16 v35, v143, v11, v35
    s_waitcnt lgkmcnt(0)
    v_readfirstlane_b32 s4, v60
    v_readfirstlane_b32 s6, v59
    s_cmp_ge_u32 s4, 1024
    s_cbranch_scc1 L_drain0
    s_cmp_ge_u32 s6, s54
    s_cbranch_scc1 L_glob0
    s_add_u32 s5, s6, s98
    v_mov_b32 v60, s5
    s_branch L_cont0
L_glob0:
    v_mov_b32 v60, 1024
    s_cmp_lg_u32 s79, 255
    s_cbranch_scc1 L_cont0
    s_mov_b64 exec, 1
    global_atomic_add v60, v62, v63, s[100:101] sc0 sc1
    s_mov_b64 exec, -1
    s_add_u32 s99, s99, 1
L_cont0:
    s_add_u32 s5, s4, s53
    s_and_b32 s5, s5, 1023
    s_and_b32 s11, s5, 15
    s_mul_i32 s11, s11, 17
    s_bfe_u32 s11, s11, 0x40001
    s_andn2_b32 s5, s5, 15
    s_or_b32 s5, s5, s11
    s_andn2_b32 s11, s5, 63
    s_add_u32 s5, s5, s11
    s_lshl_b32 s5, s5, 10
    s_add_u32 s55, s5, s52
    s_xor_b32 s56, s55, 0x4000800
    buffer_load_dwordx4 v[128:131], v1, s[40:43], s55 offen nt
    buffer_load_dwordx4 v[132:135], v55, s[40:43], s55 offen nt
    buffer_load_dwordx4 v[136:139], v1, s[40:43], s56 offen nt
    buffer_load_dwordx4 v[140:143], v55, s[40:43], s56 offen nt
    v_add_f32_dpp v32, v32, v32 row_ror:8 row_mask:0xf bank_mask:0xf
    v_add_f32_dpp v33, v33, v33 row_ror:8 row_mask:0xf bank_mask:0xf
    v_add_f32_dpp v34, v34, v34 row_ror:8 row_mask:0xf bank_mask:0xf
    v_add_f32_dpp v35, v35, v35 row_ror:8 row_mask:0xf bank_mask:0xf
    v_add_f32_dpp v32, v32, v32 row_ror:4 row_mask:0xf bank_mask:0xf
    v_add_f32_dpp v33, v33, v33 row_ror:4 row_mask:0xf bank_mask:0xf
    v_add_f32_dpp v34, v34, v34 row_ror:4 row_mask:0xf bank_mask:0xf
    v_add_f32_dpp v35, v35, v35 row_ror:4 row_mask:0xf bank_mask:0xf
    v_add_f32_dpp v32, v32, v32 row_ror:2 row_mask:0xf bank_mask:0xf
    v_add_f32_dpp v33, v33, v33 row_ror:2 row_mask:0xf bank_mask:0xf
    v_add_f32_dpp v34, v34, v34 row_ror:2 row_mask:0xf bank_mask:0xf
    v_add_f32_dpp v35, v35, v35 row_ror:2 row_mask:0xf bank_mask:0xf
    v_add_f32_dpp v32, v32, v32 row_ror:1 row_mask:0xf bank_mask:0xf
    v_add_f32_dpp v33, v33, v33 row_ror:1 row_mask:0xf bank_mask:0xf
    v_add_f32_dpp v34, v34, v34 row_ror:1 row_mask:0xf bank_mask:0xf
    v_add_f32_dpp v35, v35, v35 row_ror:1 row_mask:0xf bank_mask:0xf
    v_cvt_pk_bf16_f32 v42, v32, v33
    v_cvt_pk_bf16_f32 v43, v34, v35
    v_lshlrev_b32 v32, 16, v42
    v_and_b32 v33, 0xffff0000, v42
    v_lshlrev_b32 v34, 16, v43
    v_and_b32 v35, 0xffff0000, v43
    v_mul_f32 v32, s69, v32
    v_mul_f32 v33, s69, v33
    v_mul_f32 v34, s69, v34
    v_mul_f32 v35, s69, v35
    v_cvt_pk_bf16_f32 v42, v32, v33
    v_cvt_pk_bf16_f32 v43, v34, v35
    v_lshlrev_b32 v32, 16, v42
    v_and_b32 v33, 0xffff0000, v42
    v_lshlrev_b32 v34, 16, v43
    v_and_b32 v35, 0xffff0000, v43
    v_max3_f32 v46, v32, v33, v12
    v_max3_f32 v47, v34, v35, v14
    v_sub_f32 v48, v12, v46
    v_sub_f32 v49, v14, v47
    v_mul_f32 v40, s68, v46
    v_mul_f32 v41, s68, v47
    v_mul_f32 v48, s68, v48
    v_mul_f32 v49, s68, v49
    v_mov_b32 v12, v46
    v_mov_b32 v14, v47
    v_fma_f32 v32, v32, s68, -v40
    v_fma_f32 v33, v33, s68, -v40
    v_fma_f32 v34, v34, s68, -v41
    v_fma_f32 v35, v35, s68, -v41
    v_exp_f32 v38, v48
    v_exp_f32 v39, v49
    v_exp_f32 v32, v32
    v_exp_f32 v33, v33
    v_exp_f32 v34, v34
    v_exp_f32 v35, v35
    v_mul_f32 v16, v16, v38
    v_mul_f32 v17, v17, v38
    v_mul_f32 v18, v18, v38
    v_mul_f32 v19, v19, v38
    v_mul_f32 v20, v20, v38
    v_mul_f32 v21, v21, v38
    v_mul_f32 v22, v22, v38
    v_mul_f32 v23, v23, v38
    v_mul_f32 v24, v24, v39
    v_mul_f32 v25, v25, v39
    v_mul_f32 v26, v26, v39
    v_mul_f32 v27, v27, v39
    v_mul_f32 v28, v28, v39
    v_mul_f32 v29, v29, v39
    v_mul_f32 v30, v30, v39
    v_mul_f32 v31, v31, v39
    v_cvt_pk_bf16_f32 v36, v32, v33
    v_cvt_pk_bf16_f32 v37, v34, v35
    v_add_f32 v46, v32, v33
    v_add_f32 v47, v34, v35
    v_fma_f32 v13, v13, v38, v46
    v_fma_f32 v15, v15, v39, v47
    s_cmp_ge_u32 s99, 2
    s_cbranch_scc1 L_w14_0
    s_waitcnt vmcnt(12)
L_w14_0:
    s_waitcnt vmcnt(14)
    v_perm_b32 v42, v164, v160, s60
    v_perm_b32 v43, v164, v160, s61
    v_perm_b32 v44, v165, v161, s60
    v_perm_b32 v45, v165, v161, s61
    v_dot2_f32_bf16 v16, v42, v36, v16
    v_dot2_f32_bf16 v17, v43, v36, v17
    v_dot2_f32_bf16 v18, v44, v36, v18
    v_dot2_f32_bf16 v19, v45, v36, v19
    v_perm_b32 v42, v166, v162, s60
    v_perm_b32 v43, v166, v162, s61
    v_perm_b32 v44, v167, v163, s60
    v_perm_b32 v45, v167, v163, s61
    v_dot2_f32_bf16 v20, v42, v36, v20
    v_dot2_f32_bf16 v21, v43, v36, v21
    v_dot2_f32_bf16 v22, v44, v36, v22
    v_dot2_f32_bf16 v23, v45, v36, v23
    v_perm_b32 v46, v172, v168, s60
    v_perm_b32 v47, v172, v168, s61
    v_perm_b32 v48, v173, v169, s60
    v_perm_b32 v49, v173, v169, s61
    v_dot2_f32_bf16 v24, v46, v37, v24
    v_dot2_f32_bf16 v25, v47, v37, v25
    v_dot2_f32_bf16 v26, v48, v37, v26
    v_dot2_f32_bf16 v27, v49, v37, v27
    v_perm_b32 v46, v174, v170, s60
    v_perm_b32 v47, v174, v170, s61
    v_perm_b32 v48, v175, v171, s60
    v_perm_b32 v49, v175, v171, s61
    v_dot2_f32_bf16 v28, v46, v37, v28
    v_dot2_f32_bf16 v29, v47, v37, v29
    v_dot2_f32_bf16 v30, v48, v37, v30
    v_dot2_f32_bf16 v31, v49, v37, v31
    buffer_load_dwordx4 v[160:163], v1, s[44:47], s55 offen nt
    buffer_load_dwordx4 v[164:167], v55, s[44:47], s55 offen nt
    buffer_load_dwordx4 v[168:171], v1, s[44:47], s56 offen nt
    buffer_load_dwordx4 v[172:175], v55, s[44:47], s56 offen nt
    s_mov_b64 exec, 1
    ds_add_rtn_u32 v59, v62, v57 offset:512
    s_mov_b64 exec, -1
    s_waitcnt vmcnt(12)
    v_dot2_f32_bf16 v32, v144, v4, 0
    v_dot2_f32_bf16 v33, v148, v4, 0
    v_dot2_f32_bf16 v34, v152, v8, 0
    v_dot2_f32_bf16 v35, v156, v8, 0
    v_dot2_f32_bf16 v32, v145, v5, v32
    v_dot2_f32_bf16 v33, v149, v5, v33
    v_dot2_f32_bf16 v34, v153, v9, v34
    v_dot2_f32_bf16 v35, v157, v9, v35
    v_dot2_f32_bf16 v32, v146, v6, v32
    v_dot2_f32_bf16 v33, v150, v6, v33
    v_dot2_f32_bf16 v34, v154, v10, v34
    v_dot2_f32_bf16 v35, v158, v10, v35
    v_dot2_f32_bf16 v32, v147, v7, v32
    v_dot2_f32_bf16 v33, v151, v7, v33
    v_dot2_f32_bf16 v34, v155, v11, v34
    v_dot2_f32_bf16 v35, v159, v11, v35
    s_waitcnt lgkmcnt(0)
    v_readfirstlane_b32 s4, v61
    v_readfirstlane_b32 s6, v59
    s_cmp_ge_u32 s4, 1024
    s_cbranch_scc1 L_drain1
    s_cmp_ge_u32 s6, s54
    s_cbranch_scc1 L_glob1
    s_add_u32 s5, s6, s98
    v_mov_b32 v61, s5
    s_branch L_cont1
L_glob1:
    v_mov_b32 v61, 1024
    s_cmp_lg_u32 s79, 255
    s_cbranch_scc1 L_cont1
    s_mov_b64 exec, 1
    global_atomic_add v61, v62, v63, s[100:101] sc0 sc1
    s_mov_b64 exec, -1
    s_add_u32 s99, s99, 1
L_cont1:
    s_add_u32 s5, s4, s53
    s_and_b32 s5, s5, 1023
    s_and_b32 s11, s5, 15
    s_mul_i32 s11, s11, 17
    s_bfe_u32 s11, s11, 0x40001
    s_andn2_b32 s5, s5, 15
    s_or_b32 s5, s5, s11
    s_andn2_b32 s11, s5, 63
    s_add_u32 s5, s5, s11
    s_lshl_b32 s5, s5, 10
    s_add_u32 s55, s5, s52
    s_xor_b32 s56, s55, 0x4000800
    buffer_load_dwordx4 v[144:147], v1, s[40:43], s55 offen nt
    buffer_load_dwordx4 v[148:151], v55, s[40:43], s55 offen nt
    buffer_load_dwordx4 v[152:155], v1, s[40:43], s56 offen nt
    buffer_load_dwordx4 v[156:159], v55, s[40:43], s56 offen nt
    v_add_f32_dpp v32, v32, v32 row_ror:8 row_mask:0xf bank_mask:0xf
    v_add_f32_dpp v33, v33, v33 row_ror:8 row_mask:0xf bank_mask:0xf
    v_add_f32_dpp v34, v34, v34 row_ror:8 row_mask:0xf bank_mask:0xf
    v_add_f32_dpp v35, v35, v35 row_ror:8 row_mask:0xf bank_mask:0xf
    v_add_f32_dpp v32, v32, v32 row_ror:4 row_mask:0xf bank_mask:0xf
    v_add_f32_dpp v33, v33, v33 row_ror:4 row_mask:0xf bank_mask:0xf
    v_add_f32_dpp v34, v34, v34 row_ror:4 row_mask:0xf bank_mask:0xf
    v_add_f32_dpp v35, v35, v35 row_ror:4 row_mask:0xf bank_mask:0xf
    v_add_f32_dpp v32, v32, v32 row_ror:2 row_mask:0xf bank_mask:0xf
    v_add_f32_dpp v33, v33, v33 row_ror:2 row_mask:0xf bank_mask:0xf
    v_add_f32_dpp v34, v34, v34 row_ror:2 row_mask:0xf bank_mask:0xf
    v_add_f32_dpp v35, v35, v35 row_ror:2 row_mask:0xf bank_mask:0xf
    v_add_f32_dpp v32, v32, v32 row_ror:1 row_mask:0xf bank_mask:0xf
    v_add_f32_dpp v33, v33, v33 row_ror:1 row_mask:0xf bank_mask:0xf
    v_add_f32_dpp v34, v34, v34 row_ror:1 row_mask:0xf bank_mask:0xf
    v_add_f32_dpp v35, v35, v35 row_ror:1 row_mask:0xf bank_mask:0xf
    v_cvt_pk_bf16_f32 v42, v32, v33
    v_cvt_pk_bf16_f32 v43, v34, v35
    v_lshlrev_b32 v32, 16, v42
    v_and_b32 v33, 0xffff0000, v42
    v_lshlrev_b32 v34, 16, v43
    v_and_b32 v35, 0xffff0000, v43
    v_mul_f32 v32, s69, v32
    v_mul_f32 v33, s69, v33
    v_mul_f32 v34, s69, v34
    v_mul_f32 v35, s69, v35
    v_cvt_pk_bf16_f32 v42, v32, v33
    v_cvt_pk_bf16_f32 v43, v34, v35
    v_lshlrev_b32 v32, 16, v42
    v_and_b32 v33, 0xffff0000, v42
    v_lshlrev_b32 v34, 16, v43
    v_and_b32 v35, 0xffff0000, v43
    v_max3_f32 v46, v32, v33, v12
    v_max3_f32 v47, v34, v35, v14
    v_sub_f32 v48, v12, v46
    v_sub_f32 v49, v14, v47
    v_mul_f32 v40, s68, v46
    v_mul_f32 v41, s68, v47
    v_mul_f32 v48, s68, v48
    v_mul_f32 v49, s68, v49
    v_mov_b32 v12, v46
    v_mov_b32 v14, v47
    v_fma_f32 v32, v32, s68, -v40
    v_fma_f32 v33, v33, s68, -v40
    v_fma_f32 v34, v34, s68, -v41
    v_fma_f32 v35, v35, s68, -v41
    v_exp_f32 v38, v48
    v_exp_f32 v39, v49
    v_exp_f32 v32, v32
    v_exp_f32 v33, v33
    v_exp_f32 v34, v34
    v_exp_f32 v35, v35
    v_mul_f32 v16, v16, v38
    v_mul_f32 v17, v17, v38
    v_mul_f32 v18, v18, v38
    v_mul_f32 v19, v19, v38
    v_mul_f32 v20, v20, v38
    v_mul_f32 v21, v21, v38
    v_mul_f32 v22, v22, v38
    v_mul_f32 v23, v23, v38
    v_mul_f32 v24, v24, v39
    v_mul_f32 v25, v25, v39
    v_mul_f32 v26, v26, v39
    v_mul_f32 v27, v27, v39
    v_mul_f32 v28, v28, v39
    v_mul_f32 v29, v29, v39
    v_mul_f32 v30, v30, v39
    v_mul_f32 v31, v31, v39
    v_cvt_pk_bf16_f32 v36, v32, v33
    v_cvt_pk_bf16_f32 v37, v34, v35
    v_add_f32 v46, v32, v33
    v_add_f32 v47, v34, v35
    v_fma_f32 v13, v13, v38, v46
    v_fma_f32 v15, v15, v39, v47
    s_cmp_ge_u32 s99, 2
    s_cbranch_scc1 L_w14_1
    s_waitcnt vmcnt(12)
L_w14_1:
    s_waitcnt vmcnt(14)
    v_perm_b32 v42, v180, v176, s60
    v_perm_b32 v43, v180, v176, s61
    v_perm_b32 v44, v181, v177, s60
    v_perm_b32 v45, v181, v177, s61
    v_dot2_f32_bf16 v16, v42, v36, v16
    v_dot2_f32_bf16 v17, v43, v36, v17
    v_dot2_f32_bf16 v18, v44, v36, v18
    v_dot2_f32_bf16 v19, v45, v36, v19
    v_perm_b32 v42, v182, v178, s60
    v_perm_b32 v43, v182, v178, s61
    v_perm_b32 v44, v183, v179, s60
    v_perm_b32 v45, v183, v179, s61
    v_dot2_f32_bf16 v20, v42, v36, v20
    v_dot2_f32_bf16 v21, v43, v36, v21
    v_dot2_f32_bf16 v22, v44, v36, v22
    v_dot2_f32_bf16 v23, v45, v36, v23
    v_perm_b32 v46, v188, v184, s60
    v_perm_b32 v47, v188, v184, s61
    v_perm_b32 v48, v189, v185, s60
    v_perm_b32 v49, v189, v185, s61
    v_dot2_f32_bf16 v24, v46, v37, v24
    v_dot2_f32_bf16 v25, v47, v37, v25
    v_dot2_f32_bf16 v26, v48, v37, v26
    v_dot2_f32_bf16 v27, v49, v37, v27
    v_perm_b32 v46, v190, v186, s60
    v_perm_b32 v47, v190, v186, s61
    v_perm_b32 v48, v191, v187, s60
    v_perm_b32 v49, v191, v187, s61
    v_dot2_f32_bf16 v28, v46, v37, v28
    v_dot2_f32_bf16 v29, v47, v37, v29
    v_dot2_f32_bf16 v30, v48, v37, v30
    v_dot2_f32_bf16 v31, v49, v37, v31
    buffer_load_dwordx4 v[176:179], v1, s[44:47], s55 offen nt
    buffer_load_dwordx4 v[180:183], v55, s[44:47], s55 offen nt
    buffer_load_dwordx4 v[184:187], v1, s[44:47], s56 offen nt
    buffer_load_dwordx4 v[188:191], v55, s[44:47], s56 offen nt
    s_mov_b64 exec, 1
    ds_add_rtn_u32 v59, v62, v57 offset:512
    s_mov_b64 exec, -1
    s_cmp_lg_u32 s97, 0
    s_cbranch_scc1 L_noc
    s_waitcnt vmcnt(16)
    s_cmp_eq_u32 s79, 255
    s_cbranch_scc1 L_c_plain
    v_perm_b32 v42, v68, v64, s60
    v_perm_b32 v68, v68, v64, s61
    v_mov_b32 v64, v42
    v_perm_b32 v42, v69, v65, s60
    v_perm_b32 v43, v69, v65, s61
    v_perm_b32 v65, v76, v72, s60
    v_perm_b32 v69, v76, v72, s61
    v_mov_b32 v72, v42
    v_mov_b32 v76, v43
    v_perm_b32 v42, v70, v66, s60
    v_perm_b32 v43, v70, v66, s61
    v_perm_b32 v66, v84, v80, s60
    v_perm_b32 v70, v84, v80, s61
    v_mov_b32 v80, v42
    v_mov_b32 v84, v43
    v_perm_b32 v42, v71, v67, s60
    v_perm_b32 v43, v71, v67, s61
    v_perm_b32 v67, v92, v88, s60
    v_perm_b32 v71, v92, v88, s61
    v_mov_b32 v88, v42
    v_mov_b32 v92, v43
    v_perm_b32 v42, v77, v73, s60
    v_perm_b32 v77, v77, v73, s61
    v_mov_b32 v73, v42
    v_perm_b32 v42, v78, v74, s60
    v_perm_b32 v43, v78, v74, s61
    v_perm_b32 v74, v85, v81, s60
    v_perm_b32 v78, v85, v81, s61
    v_mov_b32 v81, v42
    v_mov_b32 v85, v43
    v_perm_b32 v42, v79, v75, s60
    v_perm_b32 v43, v79, v75, s61
    v_perm_b32 v75, v93, v89, s60
    v_perm_b32 v79, v93, v89, s61
    v_mov_b32 v89, v42
    v_mov_b32 v93, v43
    v_perm_b32 v42, v86, v82, s60
    v_perm_b32 v86, v86, v82, s61
    v_mov_b32 v82, v42
    v_perm_b32 v42, v87, v83, s60
    v_perm_b32 v43, v87, v83, s61
    v_perm_b32 v83, v94, v90, s60
    v_perm_b32 v87, v94, v90, s61
    v_mov_b32 v90, v42
    v_mov_b32 v94, v43
    v_perm_b32 v42, v95, v91, s60
    v_perm_b32 v95, v95, v91, s61
    v_mov_b32 v91, v42
    v_perm_b32 v42, v100, v96, s60
    v_perm_b32 v100, v100, v96, s61
    v_mov_b32 v96, v42
    v_perm_b32 v42, v101, v97, s60
    v_perm_b32 v43, v101, v97, s61
    v_perm_b32 v97, v108, v104, s60
    v_perm_b32 v101, v108, v104, s61
    v_mov_b32 v104, v42
    v_mov_b32 v108, v43
    v_perm_b32 v42, v102, v98, s60
    v_perm_b32 v43, v102, v98, s61
    v_perm_b32 v98, v116, v112, s60
    v_perm_b32 v102, v116, v112, s61
    v_mov_b32 v112, v42
    v_mov_b32 v116, v43
    v_perm_b32 v42, v103, v99, s60
    v_perm_b32 v43, v103, v99, s61
    v_perm_b32 v99, v124, v120, s60
    v_perm_b32 v103, v124, v120, s61
    v_mov_b32 v120, v42
    v_mov_b32 v124, v43
    v_perm_b32 v42, v109, v105, s60
    v_perm_b32 v109, v109, v105, s61
    v_mov_b32 v105, v42
    v_perm_b32 v42, v110, v106, s60
    v_perm_b32 v43, v110, v106, s61
    v_perm_b32 v106, v117, v113, s60
    v_perm_b32 v110, v117, v113, s61
    v_mov_b32 v113, v42
    v_mov_b32 v117, v43
    v_perm_b32 v42, v111, v107, s60
    v_perm_b32 v43, v111, v107, s61
    v_perm_b32 v107, v125, v121, s60
    v_perm_b32 v111, v125, v121, s61
    v_mov_b32 v121, v42
    v_mov_b32 v125, v43
    v_perm_b32 v42, v118, v114, s60
    v_perm_b32 v118, v118, v114, s61
    v_mov_b32 v114, v42
    v_perm_b32 v42, v119, v115, s60
    v_perm_b32 v43, v119, v115, s61
    v_perm_b32 v115, v126, v122, s60
    v_perm_b32 v119, v126, v122, s61
    v_mov_b32 v122, v42
    v_mov_b32 v126, v43
    v_perm_b32 v42, v127, v123, s60
    v_perm_b32 v127, v127, v123, s61
    v_mov_b32 v123, v42
    s_cmp_ge_u32 s79, 22
    s_cbranch_scc1 L_tr_doneS
    v_perm_b32 v42, v196, v192, s60
    v_perm_b32 v196, v196, v192, s61
    v_mov_b32 v192, v42
    v_perm_b32 v42, v197, v193, s60
    v_perm_b32 v43, v197, v193, s61
    v_perm_b32 v193, v204, v200, s60
    v_perm_b32 v197, v204, v200, s61
    v_mov_b32 v200, v42
    v_mov_b32 v204, v43
    v_perm_b32 v42, v198, v194, s60
    v_perm_b32 v43, v198, v194, s61
    v_perm_b32 v194, v212, v208, s60
    v_perm_b32 v198, v212, v208, s61
    v_mov_b32 v208, v42
    v_mov_b32 v212, v43
    v_perm_b32 v42, v199, v195, s60
    v_perm_b32 v43, v199, v195, s61
    v_perm_b32 v195, v220, v216, s60
    v_perm_b32 v199, v220, v216, s61
    v_mov_b32 v216, v42
    v_mov_b32 v220, v43
    v_perm_b32 v42, v205, v201, s60
    v_perm_b32 v205, v205, v201, s61
    v_mov_b32 v201, v42
    v_perm_b32 v42, v206, v202, s60
    v_perm_b32 v43, v206, v202, s61
    v_perm_b32 v202, v213, v209, s60
    v_perm_b32 v206, v213, v209, s61
    v_mov_b32 v209, v42
    v_mov_b32 v213, v43
    v_perm_b32 v42, v207, v203, s60
    v_perm_b32 v43, v207, v203, s61
    v_perm_b32 v203, v221, v217, s60
    v_perm_b32 v207, v221, v217, s61
    v_mov_b32 v217, v42
    v_mov_b32 v221, v43
    v_perm_b32 v42, v214, v210, s60
    v_perm_b32 v214, v214, v210, s61
    v_mov_b32 v210, v42
    v_perm_b32 v42, v215, v211, s60
    v_perm_b32 v43, v215, v211, s61
    v_perm_b32 v211, v222, v218, s60
    v_perm_b32 v215, v222, v218, s61
    v_mov_b32 v218, v42
    v_mov_b32 v222, v43
    v_perm_b32 v42, v223, v219, s60
    v_perm_b32 v223, v223, v219, s61
    v_mov_b32 v219, v42
    v_perm_b32 v42, v228, v224, s60
    v_perm_b32 v228, v228, v224, s61
    v_mov_b32 v224, v42
    v_perm_b32 v42, v229, v225, s60
    v_perm_b32 v43, v229, v225, s61
    v_perm_b32 v225, v236, v232, s60
    v_perm_b32 v229, v236, v232, s61
    v_mov_b32 v232, v42
    v_mov_b32 v236, v43
    v_perm_b32 v42, v230, v226, s60
    v_perm_b32 v43, v230, v226, s61
    v_perm_b32 v226, v244, v240, s60
    v_perm_b32 v230, v244, v240, s61
    v_mov_b32 v240, v42
    v_mov_b32 v244, v43
    v_perm_b32 v42, v231, v227, s60
    v_perm_b32 v43, v231, v227, s61
    v_perm_b32 v227, v252, v248, s60
    v_perm_b32 v231, v252, v248, s61
    v_mov_b32 v248, v42
    v_mov_b32 v252, v43
    v_perm_b32 v42, v237, v233, s60
    v_perm_b32 v237, v237, v233, s61
    v_mov_b32 v233, v42
    v_perm_b32 v42, v238, v234, s60
    v_perm_b32 v43, v238, v234, s61
    v_perm_b32 v234, v245, v241, s60
    v_perm_b32 v238, v245, v241, s61
    v_mov_b32 v241, v42
    v_mov_b32 v245, v43
    v_perm_b32 v42, v239, v235, s60
    v_perm_b32 v43, v239, v235, s61
    v_perm_b32 v235, v253, v249, s60
    v_perm_b32 v239, v253, v249, s61
    v_mov_b32 v249, v42
    v_mov_b32 v253, v43
    v_perm_b32 v42, v246, v242, s60
    v_perm_b32 v246, v246, v242, s61
    v_mov_b32 v242, v42
    v_perm_b32 v42, v247, v243, s60
    v_perm_b32 v43, v247, v243, s61
    v_perm_b32 v243, v254, v250, s60
    v_perm_b32 v247, v254, v250, s61
    v_mov_b32 v250, v42
    v_mov_b32 v254, v43
    v_perm_b32 v42, v255, v251, s60
    v_perm_b32 v255, v255, v251, s61
    v_mov_b32 v251, v42
L_tr_doneS:
    s_branch L_noc
L_c_plain:
    v_dot2_f32_bf16 v32, v192, v4, 0
    v_dot2_f32_bf16 v33, v196, v4, 0
    v_dot2_f32_bf16 v34, v200, v8, 0
    v_dot2_f32_bf16 v35, v204, v8, 0
    v_dot2_f32_bf16 v32, v193, v5, v32
    v_dot2_f32_bf16 v33, v197, v5, v33
    v_dot2_f32_bf16 v34, v201, v9, v34
    v_dot2_f32_bf16 v35, v205, v9, v35
    v_dot2_f32_bf16 v32, v194, v6, v32
    v_dot2_f32_bf16 v33, v198, v6, v33
    v_dot2_f32_bf16 v34, v202, v10, v34
    v_dot2_f32_bf16 v35, v206, v10, v35
    v_dot2_f32_bf16 v32, v195, v7, v32
    v_dot2_f32_bf16 v33, v199, v7, v33
    v_dot2_f32_bf16 v34, v203, v11, v34
    v_dot2_f32_bf16 v35, v207, v11, v35
    v_add_f32_dpp v32, v32, v32 row_ror:8 row_mask:0xf bank_mask:0xf
    v_add_f32_dpp v33, v33, v33 row_ror:8 row_mask:0xf bank_mask:0xf
    v_add_f32_dpp v34, v34, v34 row_ror:8 row_mask:0xf bank_mask:0xf
    v_add_f32_dpp v35, v35, v35 row_ror:8 row_mask:0xf bank_mask:0xf
    v_add_f32_dpp v32, v32, v32 row_ror:4 row_mask:0xf bank_mask:0xf
    v_add_f32_dpp v33, v33, v33 row_ror:4 row_mask:0xf bank_mask:0xf
    v_add_f32_dpp v34, v34, v34 row_ror:4 row_mask:0xf bank_mask:0xf
    v_add_f32_dpp v35, v35, v35 row_ror:4 row_mask:0xf bank_mask:0xf
    v_add_f32_dpp v32, v32, v32 row_ror:2 row_mask:0xf bank_mask:0xf
    v_add_f32_dpp v33, v33, v33 row_ror:2 row_mask:0xf bank_mask:0xf
    v_add_f32_dpp v34, v34, v34 row_ror:2 row_mask:0xf bank_mask:0xf
    v_add_f32_dpp v35, v35, v35 row_ror:2 row_mask:0xf bank_mask:0xf
    v_add_f32_dpp v32, v32, v32 row_ror:1 row_mask:0xf bank_mask:0xf
    v_add_f32_dpp v33, v33, v33 row_ror:1 row_mask:0xf bank_mask:0xf
    v_add_f32_dpp v34, v34, v34 row_ror:1 row_mask:0xf bank_mask:0xf
    v_add_f32_dpp v35, v35, v35 row_ror:1 row_mask:0xf bank_mask:0xf
    v_cvt_pk_bf16_f32 v42, v32, v33
    v_cvt_pk_bf16_f32 v43, v34, v35
    v_lshlrev_b32 v32, 16, v42
    v_and_b32 v33, 0xffff0000, v42
    v_lshlrev_b32 v34, 16, v43
    v_and_b32 v35, 0xffff0000, v43
    v_mul_f32 v32, s69, v32
    v_mul_f32 v33, s69, v33
    v_mul_f32 v34, s69, v34
    v_mul_f32 v35, s69, v35
    v_cvt_pk_bf16_f32 v42, v32, v33
    v_cvt_pk_bf16_f32 v43, v34, v35
    v_lshlrev_b32 v32, 16, v42
    v_and_b32 v33, 0xffff0000, v42
    v_lshlrev_b32 v34, 16, v43
    v_and_b32 v35, 0xffff0000, v43
    v_max3_f32 v46, v32, v33, v12
    v_max3_f32 v47, v34, v35, v14
    v_sub_f32 v48, v12, v46
    v_sub_f32 v49, v14, v47
    v_mul_f32 v40, s68, v46
    v_mul_f32 v41, s68, v47
    v_mul_f32 v48, s68, v48
    v_mul_f32 v49, s68, v49
    v_mov_b32 v12, v46
    v_mov_b32 v14, v47
    v_fma_f32 v32, v32, s68, -v40
    v_fma_f32 v33, v33, s68, -v40
    v_fma_f32 v34, v34, s68, -v41
    v_fma_f32 v35, v35, s68, -v41
    v_exp_f32 v38, v48
    v_exp_f32 v39, v49
    v_exp_f32 v32, v32
    v_exp_f32 v33, v33
    v_exp_f32 v34, v34
    v_exp_f32 v35, v35
    v_mul_f32 v16, v16, v38
    v_mul_f32 v17, v17, v38
    v_mul_f32 v18, v18, v38
    v_mul_f32 v19, v19, v38
    v_mul_f32 v20, v20, v38
    v_mul_f32 v21, v21, v38
    v_mul_f32 v22, v22, v38
    v_mul_f32 v23, v23, v38
    v_mul_f32 v24, v24, v39
    v_mul_f32 v25, v25, v39
    v_mul_f32 v26, v26, v39
    v_mul_f32 v27, v27, v39
    v_mul_f32 v28, v28, v39
    v_mul_f32 v29, v29, v39
    v_mul_f32 v30, v30, v39
    v_mul_f32 v31, v31, v39
    v_cvt_pk_bf16_f32 v36, v32, v33
    v_cvt_pk_bf16_f32 v37, v34, v35
    v_add_f32 v46, v32, v33
    v_add_f32 v47, v34, v35
    v_fma_f32 v13, v13, v38, v46
    v_fma_f32 v15, v15, v39, v47
    v_perm_b32 v42, v228, v224, s60
    v_perm_b32 v43, v228, v224, s61
    v_perm_b32 v44, v229, v225, s60
    v_perm_b32 v45, v229, v225, s61
    v_dot2_f32_bf16 v16, v42, v36, v16
    v_dot2_f32_bf16 v17, v43, v36, v17
    v_dot2_f32_bf16 v18, v44, v36, v18
    v_dot2_f32_bf16 v19, v45, v36, v19
    v_perm_b32 v42, v230, v226, s60
    v_perm_b32 v43, v230, v226, s61
    v_perm_b32 v44, v231, v227, s60
    v_perm_b32 v45, v231, v227, s61
    v_dot2_f32_bf16 v20, v42, v36, v20
    v_dot2_f32_bf16 v21, v43, v36, v21
    v_dot2_f32_bf16 v22, v44, v36, v22
    v_dot2_f32_bf16 v23, v45, v36, v23
    v_perm_b32 v46, v236, v232, s60
    v_perm_b32 v47, v236, v232, s61
    v_perm_b32 v48, v237, v233, s60
    v_perm_b32 v49, v237, v233, s61
    v_dot2_f32_bf16 v24, v46, v37, v24
    v_dot2_f32_bf16 v25, v47, v37, v25
    v_dot2_f32_bf16 v26, v48, v37, v26
    v_dot2_f32_bf16 v27, v49, v37, v27
    v_perm_b32 v46, v238, v234, s60
    v_perm_b32 v47, v238, v234, s61
    v_perm_b32 v48, v239, v235, s60
    v_perm_b32 v49, v239, v235, s61
    v_dot2_f32_bf16 v28, v46, v37, v28
    v_dot2_f32_bf16 v29, v47, v37, v29
    v_dot2_f32_bf16 v30, v48, v37, v30
    v_dot2_f32_bf16 v31, v49, v37, v31
    v_dot2_f32_bf16 v32, v208, v4, 0
    v_dot2_f32_bf16 v33, v212, v4, 0
    v_dot2_f32_bf16 v34, v216, v8, 0
    v_dot2_f32_bf16 v35, v220, v8, 0
    v_dot2_f32_bf16 v32, v209, v5, v32
    v_dot2_f32_bf16 v33, v213, v5, v33
    v_dot2_f32_bf16 v34, v217, v9, v34
    v_dot2_f32_bf16 v35, v221, v9, v35
    v_dot2_f32_bf16 v32, v210, v6, v32
    v_dot2_f32_bf16 v33, v214, v6, v33
    v_dot2_f32_bf16 v34, v218, v10, v34
    v_dot2_f32_bf16 v35, v222, v10, v35
    v_dot2_f32_bf16 v32, v211, v7, v32
    v_dot2_f32_bf16 v33, v215, v7, v33
    v_dot2_f32_bf16 v34, v219, v11, v34
    v_dot2_f32_bf16 v35, v223, v11, v35
    v_add_f32_dpp v32, v32, v32 row_ror:8 row_mask:0xf bank_mask:0xf
    v_add_f32_dpp v33, v33, v33 row_ror:8 row_mask:0xf bank_mask:0xf
    v_add_f32_dpp v34, v34, v34 row_ror:8 row_mask:0xf bank_mask:0xf
    v_add_f32_dpp v35, v35, v35 row_ror:8 row_mask:0xf bank_mask:0xf
    v_add_f32_dpp v32, v32, v32 row_ror:4 row_mask:0xf bank_mask:0xf
    v_add_f32_dpp v33, v33, v33 row_ror:4 row_mask:0xf bank_mask:0xf
    v_add_f32_dpp v34, v34, v34 row_ror:4 row_mask:0xf bank_mask:0xf
    v_add_f32_dpp v35, v35, v35 row_ror:4 row_mask:0xf bank_mask:0xf
    v_add_f32_dpp v32, v32, v32 row_ror:2 row_mask:0xf bank_mask:0xf
    v_add_f32_dpp v33, v33, v33 row_ror:2 row_mask:0xf bank_mask:0xf
    v_add_f32_dpp v34, v34, v34 row_ror:2 row_mask:0xf bank_mask:0xf
    v_add_f32_dpp v35, v35, v35 row_ror:2 row_mask:0xf bank_mask:0xf
    v_add_f32_dpp v32, v32, v32 row_ror:1 row_mask:0xf bank_mask:0xf
    v_add_f32_dpp v33, v33, v33 row_ror:1 row_mask:0xf bank_mask:0xf
    v_add_f32_dpp v34, v34, v34 row_ror:1 row_mask:0xf bank_mask:0xf
    v_add_f32_dpp v35, v35, v35 row_ror:1 row_mask:0xf bank_mask:0xf
    v_cvt_pk_bf16_f32 v42, v32, v33
    v_cvt_pk_bf16_f32 v43, v34, v35
    v_lshlrev_b32 v32, 16, v42
    v_and_b32 v33, 0xffff0000, v42
    v_lshlrev_b32 v34, 16, v43
    v_and_b32 v35, 0xffff0000, v43
    v_mul_f32 v32, s69, v32
    v_mul_f32 v33, s69, v33
    v_mul_f32 v34, s69, v34
    v_mul_f32 v35, s69, v35
    v_cvt_pk_bf16_f32 v42, v32, v33
    v_cvt_pk_bf16_f32 v43, v34, v35
    v_lshlrev_b32 v32, 16, v42
    v_and_b32 v33, 0xffff0000, v42
    v_lshlrev_b32 v34, 16, v43
    v_and_b32 v35, 0xffff0000, v43
    v_max3_f32 v46, v32, v33, v12
    v_max3_f32 v47, v34, v35, v14
    v_sub_f32 v48, v12, v46
    v_sub_f32 v49, v14, v47
    v_mul_f32 v40, s68, v46
    v_mul_f32 v41, s68, v47
    v_mul_f32 v48, s68, v48
    v_mul_f32 v49, s68, v49
    v_mov_b32 v12, v46
    v_mov_b32 v14, v47
    v_fma_f32 v32, v32, s68, -v40
    v_fma_f32 v33, v33, s68, -v40
    v_fma_f32 v34, v34, s68, -v41
    v_fma_f32 v35, v35, s68, -v41
    v_exp_f32 v38, v48
    v_exp_f32 v39, v49
    v_exp_f32 v32, v32
    v_exp_f32 v33, v33
    v_exp_f32 v34, v34
    v_exp_f32 v35, v35
    v_mul_f32 v16, v16, v38
    v_mul_f32 v17, v17, v38
    v_mul_f32 v18, v18, v38
    v_mul_f32 v19, v19, v38
    v_mul_f32 v20, v20, v38
    v_mul_f32 v21, v21, v38
    v_mul_f32 v22, v22, v38
    v_mul_f32 v23, v23, v38
    v_mul_f32 v24, v24, v39
    v_mul_f32 v25, v25, v39
    v_mul_f32 v26, v26, v39
    v_mul_f32 v27, v27, v39
    v_mul_f32 v28, v28, v39
    v_mul_f32 v29, v29, v39
    v_mul_f32 v30, v30, v39
    v_mul_f32 v31, v31, v39
    v_cvt_pk_bf16_f32 v36, v32, v33
    v_cvt_pk_bf16_f32 v37, v34, v35
    v_add_f32 v46, v32, v33
    v_add_f32 v47, v34, v35
    v_fma_f32 v13, v13, v38, v46
    v_fma_f32 v15, v15, v39, v47
    v_perm_b32 v42, v244, v240, s60
    v_perm_b32 v43, v244, v240, s61
    v_perm_b32 v44, v245, v241, s60
    v_perm_b32 v45, v245, v241, s61
    v_dot2_f32_bf16 v16, v42, v36, v16
    v_dot2_f32_bf16 v17, v43, v36, v17
    v_dot2_f32_bf16 v18, v44, v36, v18
    v_dot2_f32_bf16 v19, v45, v36, v19
    v_perm_b32 v42, v246, v242, s60
    v_perm_b32 v43, v246, v242, s61
    v_perm_b32 v44, v247, v243, s60
    v_perm_b32 v45, v247, v243, s61
    v_dot2_f32_bf16 v20, v42, v36, v20
    v_dot2_f32_bf16 v21, v43, v36, v21
    v_dot2_f32_bf16 v22, v44, v36, v22
    v_dot2_f32_bf16 v23, v45, v36, v23
    v_perm_b32 v46, v252, v248, s60
    v_perm_b32 v47, v252, v248, s61
    v_perm_b32 v48, v253, v249, s60
    v_perm_b32 v49, v253, v249, s61
    v_dot2_f32_bf16 v24, v46, v37, v24
    v_dot2_f32_bf16 v25, v47, v37, v25
    v_dot2_f32_bf16 v26, v48, v37, v26
    v_dot2_f32_bf16 v27, v49, v37, v27
    v_perm_b32 v46, v254, v250, s60
    v_perm_b32 v47, v254, v250, s61
    v_perm_b32 v48, v255, v251, s60
    v_perm_b32 v49, v255, v251, s61
    v_dot2_f32_bf16 v28, v46, v37, v28
    v_dot2_f32_bf16 v29, v47, v37, v29
    v_dot2_f32_bf16 v30, v48, v37, v30
    v_dot2_f32_bf16 v31, v49, v37, v31
    v_dot2_f32_bf16 v32, v64, v4, 0
    v_dot2_f32_bf16 v33, v68, v4, 0
    v_dot2_f32_bf16 v34, v72, v8, 0
    v_dot2_f32_bf16 v35, v76, v8, 0
    v_dot2_f32_bf16 v32, v65, v5, v32
    v_dot2_f32_bf16 v33, v69, v5, v33
    v_dot2_f32_bf16 v34, v73, v9, v34
    v_dot2_f32_bf16 v35, v77, v9, v35
    v_dot2_f32_bf16 v32, v66, v6, v32
    v_dot2_f32_bf16 v33, v70, v6, v33
    v_dot2_f32_bf16 v34, v74, v10, v34
    v_dot2_f32_bf16 v35, v78, v10, v35
    v_dot2_f32_bf16 v32, v67, v7, v32
    v_dot2_f32_bf16 v33, v71, v7, v33
    v_dot2_f32_bf16 v34, v75, v11, v34
    v_dot2_f32_bf16 v35, v79, v11, v35
    v_add_f32_dpp v32, v32, v32 row_ror:8 row_mask:0xf bank_mask:0xf
    v_add_f32_dpp v33, v33, v33 row_ror:8 row_mask:0xf bank_mask:0xf
    v_add_f32_dpp v34, v34, v34 row_ror:8 row_mask:0xf bank_mask:0xf
    v_add_f32_dpp v35, v35, v35 row_ror:8 row_mask:0xf bank_mask:0xf
    v_add_f32_dpp v32, v32, v32 row_ror:4 row_mask:0xf bank_mask:0xf
    v_add_f32_dpp v33, v33, v33 row_ror:4 row_mask:0xf bank_mask:0xf
    v_add_f32_dpp v34, v34, v34 row_ror:4 row_mask:0xf bank_mask:0xf
    v_add_f32_dpp v35, v35, v35 row_ror:4 row_mask:0xf bank_mask:0xf
    v_add_f32_dpp v32, v32, v32 row_ror:2 row_mask:0xf bank_mask:0xf
    v_add_f32_dpp v33, v33, v33 row_ror:2 row_mask:0xf bank_mask:0xf
    v_add_f32_dpp v34, v34, v34 row_ror:2 row_mask:0xf bank_mask:0xf
    v_add_f32_dpp v35, v35, v35 row_ror:2 row_mask:0xf bank_mask:0xf
    v_add_f32_dpp v32, v32, v32 row_ror:1 row_mask:0xf bank_mask:0xf
    v_add_f32_dpp v33, v33, v33 row_ror:1 row_mask:0xf bank_mask:0xf
    v_add_f32_dpp v34, v34, v34 row_ror:1 row_mask:0xf bank_mask:0xf
    v_add_f32_dpp v35, v35, v35 row_ror:1 row_mask:0xf bank_mask:0xf
    v_cvt_pk_bf16_f32 v42, v32, v33
    v_cvt_pk_bf16_f32 v43, v34, v35
    v_lshlrev_b32 v32, 16, v42
    v_and_b32 v33, 0xffff0000, v42
    v_lshlrev_b32 v34, 16, v43
    v_and_b32 v35, 0xffff0000, v43
    v_mul_f32 v32, s69, v32
    v_mul_f32 v33, s69, v33
    v_mul_f32 v34, s69, v34
    v_mul_f32 v35, s69, v35
    v_cvt_pk_bf16_f32 v42, v32, v33
    v_cvt_pk_bf16_f32 v43, v34, v35
    v_lshlrev_b32 v32, 16, v42
    v_and_b32 v33, 0xffff0000, v42
    v_lshlrev_b32 v34, 16, v43
    v_and_b32 v35, 0xffff0000, v43
    v_max3_f32 v46, v32, v33, v12
    v_max3_f32 v47, v34, v35, v14
    v_sub_f32 v48, v12, v46
    v_sub_f32 v49, v14, v47
    v_mul_f32 v40, s68, v46
    v_mul_f32 v41, s68, v47
    v_mul_f32 v48, s68, v48
    v_mul_f32 v49, s68, v49
    v_mov_b32 v12, v46
    v_mov_b32 v14, v47
    v_fma_f32 v32, v32, s68, -v40
    v_fma_f32 v33, v33, s68, -v40
    v_fma_f32 v34, v34, s68, -v41
    v_fma_f32 v35, v35, s68, -v41
    v_exp_f32 v38, v48
    v_exp_f32 v39, v49
    v_exp_f32 v32, v32
    v_exp_f32 v33, v33
    v_exp_f32 v34, v34
    v_exp_f32 v35, v35
    v_mul_f32 v16, v16, v38
    v_mul_f32 v17, v17, v38
    v_mul_f32 v18, v18, v38
    v_mul_f32 v19, v19, v38
    v_mul_f32 v20, v20, v38
    v_mul_f32 v21, v21, v38
    v_mul_f32 v22, v22, v38
    v_mul_f32 v23, v23, v38
    v_mul_f32 v24, v24, v39
    v_mul_f32 v25, v25, v39
    v_mul_f32 v26, v26, v39
    v_mul_f32 v27, v27, v39
    v_mul_f32 v28, v28, v39
    v_mul_f32 v29, v29, v39
    v_mul_f32 v30, v30, v39
    v_mul_f32 v31, v31, v39
    v_cvt_pk_bf16_f32 v36, v32, v33
    v_cvt_pk_bf16_f32 v37, v34, v35
    v_add_f32 v46, v32, v33
    v_add_f32 v47, v34, v35
    v_fma_f32 v13, v13, v38, v46
    v_fma_f32 v15, v15, v39, v47
    v_perm_b32 v42, v100, v96, s60
    v_perm_b32 v43, v100, v96, s61
    v_perm_b32 v44, v101, v97, s60
    v_perm_b32 v45, v101, v97, s61
    v_dot2_f32_bf16 v16, v42, v36, v16
    v_dot2_f32_bf16 v17, v43, v36, v17
    v_dot2_f32_bf16 v18, v44, v36, v18
    v_dot2_f32_bf16 v19, v45, v36, v19
    v_perm_b32 v42, v102, v98, s60
    v_perm_b32 v43, v102, v98, s61
    v_perm_b32 v44, v103, v99, s60
    v_perm_b32 v45, v103, v99, s61
    v_dot2_f32_bf16 v20, v42, v36, v20
    v_dot2_f32_bf16 v21, v43, v36, v21
    v_dot2_f32_bf16 v22, v44, v36, v22
    v_dot2_f32_bf16 v23, v45, v36, v23
    v_perm_b32 v46, v108, v104, s60
    v_perm_b32 v47, v108, v104, s61
    v_perm_b32 v48, v109, v105, s60
    v_perm_b32 v49, v109, v105, s61
    v_dot2_f32_bf16 v24, v46, v37, v24
    v_dot2_f32_bf16 v25, v47, v37, v25
    v_dot2_f32_bf16 v26, v48, v37, v26
    v_dot2_f32_bf16 v27, v49, v37, v27
    v_perm_b32 v46, v110, v106, s60
    v_perm_b32 v47, v110, v106, s61
    v_perm_b32 v48, v111, v107, s60
    v_perm_b32 v49, v111, v107, s61
    v_dot2_f32_bf16 v28, v46, v37, v28
    v_dot2_f32_bf16 v29, v47, v37, v29
    v_dot2_f32_bf16 v30, v48, v37, v30
    v_dot2_f32_bf16 v31, v49, v37, v31
    v_dot2_f32_bf16 v32, v80, v4, 0
    v_dot2_f32_bf16 v33, v84, v4, 0
    v_dot2_f32_bf16 v34, v88, v8, 0
    v_dot2_f32_bf16 v35, v92, v8, 0
    v_dot2_f32_bf16 v32, v81, v5, v32
    v_dot2_f32_bf16 v33, v85, v5, v33
    v_dot2_f32_bf16 v34, v89, v9, v34
    v_dot2_f32_bf16 v35, v93, v9, v35
    v_dot2_f32_bf16 v32, v82, v6, v32
    v_dot2_f32_bf16 v33, v86, v6, v33
    v_dot2_f32_bf16 v34, v90, v10, v34
    v_dot2_f32_bf16 v35, v94, v10, v35
    v_dot2_f32_bf16 v32, v83, v7, v32
    v_dot2_f32_bf16 v33, v87, v7, v33
    v_dot2_f32_bf16 v34, v91, v11, v34
    v_dot2_f32_bf16 v35, v95, v11, v35
    v_add_f32_dpp v32, v32, v32 row_ror:8 row_mask:0xf bank_mask:0xf
    v_add_f32_dpp v33, v33, v33 row_ror:8 row_mask:0xf bank_mask:0xf
    v_add_f32_dpp v34, v34, v34 row_ror:8 row_mask:0xf bank_mask:0xf
    v_add_f32_dpp v35, v35, v35 row_ror:8 row_mask:0xf bank_mask:0xf
    v_add_f32_dpp v32, v32, v32 row_ror:4 row_mask:0xf bank_mask:0xf
    v_add_f32_dpp v33, v33, v33 row_ror:4 row_mask:0xf bank_mask:0xf
    v_add_f32_dpp v34, v34, v34 row_ror:4 row_mask:0xf bank_mask:0xf
    v_add_f32_dpp v35, v35, v35 row_ror:4 row_mask:0xf bank_mask:0xf
    v_add_f32_dpp v32, v32, v32 row_ror:2 row_mask:0xf bank_mask:0xf
    v_add_f32_dpp v33, v33, v33 row_ror:2 row_mask:0xf bank_mask:0xf
    v_add_f32_dpp v34, v34, v34 row_ror:2 row_mask:0xf bank_mask:0xf
    v_add_f32_dpp v35, v35, v35 row_ror:2 row_mask:0xf bank_mask:0xf
    v_add_f32_dpp v32, v32, v32 row_ror:1 row_mask:0xf bank_mask:0xf
    v_add_f32_dpp v33, v33, v33 row_ror:1 row_mask:0xf bank_mask:0xf
    v_add_f32_dpp v34, v34, v34 row_ror:1 row_mask:0xf bank_mask:0xf
    v_add_f32_dpp v35, v35, v35 row_ror:1 row_mask:0xf bank_mask:0xf
    v_cvt_pk_bf16_f32 v42, v32, v33
    v_cvt_pk_bf16_f32 v43, v34, v35
    v_lshlrev_b32 v32, 16, v42
    v_and_b32 v33, 0xffff0000, v42
    v_lshlrev_b32 v34, 16, v43
    v_and_b32 v35, 0xffff0000, v43
    v_mul_f32 v32, s69, v32
    v_mul_f32 v33, s69, v33
    v_mul_f32 v34, s69, v34
    v_mul_f32 v35, s69, v35
    v_cvt_pk_bf16_f32 v42, v32, v33
    v_cvt_pk_bf16_f32 v43, v34, v35
    v_lshlrev_b32 v32, 16, v42
    v_and_b32 v33, 0xffff0000, v42
    v_lshlrev_b32 v34, 16, v43
    v_and_b32 v35, 0xffff0000, v43
    v_max3_f32 v46, v32, v33, v12
    v_max3_f32 v47, v34, v35, v14
    v_sub_f32 v48, v12, v46
    v_sub_f32 v49, v14, v47
    v_mul_f32 v40, s68, v46
    v_mul_f32 v41, s68, v47
    v_mul_f32 v48, s68, v48
    v_mul_f32 v49, s68, v49
    v_mov_b32 v12, v46
    v_mov_b32 v14, v47
    v_fma_f32 v32, v32, s68, -v40
    v_fma_f32 v33, v33, s68, -v40
    v_fma_f32 v34, v34, s68, -v41
    v_fma_f32 v35, v35, s68, -v41
    v_exp_f32 v38, v48
    v_exp_f32 v39, v49
    v_exp_f32 v32, v32
    v_exp_f32 v33, v33
    v_exp_f32 v34, v34
    v_exp_f32 v35, v35
    v_mul_f32 v16, v16, v38
    v_mul_f32 v17, v17, v38
    v_mul_f32 v18, v18, v38
    v_mul_f32 v19, v19, v38
    v_mul_f32 v20, v20, v38
    v_mul_f32 v21, v21, v38
    v_mul_f32 v22, v22, v38
    v_mul_f32 v23, v23, v38
    v_mul_f32 v24, v24, v39
    v_mul_f32 v25, v25, v39
    v_mul_f32 v26, v26, v39
    v_mul_f32 v27, v27, v39
    v_mul_f32 v28, v28, v39
    v_mul_f32 v29, v29, v39
    v_mul_f32 v30, v30, v39
    v_mul_f32 v31, v31, v39
    v_cvt_pk_bf16_f32 v36, v32, v33
    v_cvt_pk_bf16_f32 v37, v34, v35
    v_add_f32 v46, v32, v33
    v_add_f32 v47, v34, v35
    v_fma_f32 v13, v13, v38, v46
    v_fma_f32 v15, v15, v39, v47
    v_perm_b32 v42, v116, v112, s60
    v_perm_b32 v43, v116, v112, s61
    v_perm_b32 v44, v117, v113, s60
    v_perm_b32 v45, v117, v113, s61
    v_dot2_f32_bf16 v16, v42, v36, v16
    v_dot2_f32_bf16 v17, v43, v36, v17
    v_dot2_f32_bf16 v18, v44, v36, v18
    v_dot2_f32_bf16 v19, v45, v36, v19
    v_perm_b32 v42, v118, v114, s60
    v_perm_b32 v43, v118, v114, s61
    v_perm_b32 v44, v119, v115, s60
    v_perm_b32 v45, v119, v115, s61
    v_dot2_f32_bf16 v20, v42, v36, v20
    v_dot2_f32_bf16 v21, v43, v36, v21
    v_dot2_f32_bf16 v22, v44, v36, v22
    v_dot2_f32_bf16 v23, v45, v36, v23
    v_perm_b32 v46, v124, v120, s60
    v_perm_b32 v47, v124, v120, s61
    v_perm_b32 v48, v125, v121, s60
    v_perm_b32 v49, v125, v121, s61
    v_dot2_f32_bf16 v24, v46, v37, v24
    v_dot2_f32_bf16 v25, v47, v37, v25
    v_dot2_f32_bf16 v26, v48, v37, v26
    v_dot2_f32_bf16 v27, v49, v37, v27
    v_perm_b32 v46, v126, v122, s60
    v_perm_b32 v47, v126, v122, s61
    v_perm_b32 v48, v127, v123, s60
    v_perm_b32 v49, v127, v123, s61
    v_dot2_f32_bf16 v28, v46, v37, v28
    v_dot2_f32_bf16 v29, v47, v37, v29
    v_dot2_f32_bf16 v30, v48, v37, v30
    v_dot2_f32_bf16 v31, v49, v37, v31
L_noc:
    s_add_u32 s97, s97, 1
    s_cmp_lt_u32 s97, 600
    s_cbranch_scc1 L_loop
    s_branch L_loop_done
L_tch6:
    s_branch L_touch_ret
L_drain0:
    v_add_f32_dpp v32, v32, v32 row_ror:8 row_mask:0xf bank_mask:0xf
    v_add_f32_dpp v33, v33, v33 row_ror:8 row_mask:0xf bank_mask:0xf
    v_add_f32_dpp v34, v34, v34 row_ror:8 row_mask:0xf bank_mask:0xf
    v_add_f32_dpp v35, v35, v35 row_ror:8 row_mask:0xf bank_mask:0xf
    v_add_f32_dpp v32, v32, v32 row_ror:4 row_mask:0xf bank_mask:0xf
    v_add_f32_dpp v33, v33, v33 row_ror:4 row_mask:0xf bank_mask:0xf
    v_add_f32_dpp v34, v34, v34 row_ror:4 row_mask:0xf bank_mask:0xf
    v_add_f32_dpp v35, v35, v35 row_ror:4 row_mask:0xf bank_mask:0xf
    v_add_f32_dpp v32, v32, v32 row_ror:2 row_mask:0xf bank_mask:0xf
    v_add_f32_dpp v33, v33, v33 row_ror:2 row_mask:0xf bank_mask:0xf
    v_add_f32_dpp v34, v34, v34 row_ror:2 row_mask:0xf bank_mask:0xf
    v_add_f32_dpp v35, v35, v35 row_ror:2 row_mask:0xf bank_mask:0xf
    v_add_f32_dpp v32, v32, v32 row_ror:1 row_mask:0xf bank_mask:0xf
    v_add_f32_dpp v33, v33, v33 row_ror:1 row_mask:0xf bank_mask:0xf
    v_add_f32_dpp v34, v34, v34 row_ror:1 row_mask:0xf bank_mask:0xf
    v_add_f32_dpp v35, v35, v35 row_ror:1 row_mask:0xf bank_mask:0xf
    v_cvt_pk_bf16_f32 v42, v32, v33
    v_cvt_pk_bf16_f32 v43, v34, v35
    v_lshlrev_b32 v32, 16, v42
    v_and_b32 v33, 0xffff0000, v42
    v_lshlrev_b32 v34, 16, v43
    v_and_b32 v35, 0xffff0000, v43
    v_mul_f32 v32, s69, v32
    v_mul_f32 v33, s69, v33
    v_mul_f32 v34, s69, v34
    v_mul_f32 v35, s69, v35
    v_cvt_pk_bf16_f32 v42, v32, v33
    v_cvt_pk_bf16_f32 v43, v34, v35
    v_lshlrev_b32 v32, 16, v42
    v_and_b32 v33, 0xffff0000, v42
    v_lshlrev_b32 v34, 16, v43
    v_and_b32 v35, 0xffff0000, v43
    v_max3_f32 v46, v32, v33, v12
    v_max3_f32 v47, v34, v35, v14
    v_sub_f32 v48, v12, v46
    v_sub_f32 v49, v14, v47
    v_mul_f32 v40, s68, v46
    v_mul_f32 v41, s68, v47
    v_mul_f32 v48, s68, v48
    v_mul_f32 v49, s68, v49
    v_mov_b32 v12, v46
    v_mov_b32 v14, v47
    v_fma_f32 v32, v32, s68, -v40
    v_fma_f32 v33, v33, s68, -v40
    v_fma_f32 v34, v34, s68, -v41
    v_fma_f32 v35, v35, s68, -v41
    v_exp_f32 v38, v48
    v_exp_f32 v39, v49
    v_exp_f32 v32, v32
    v_exp_f32 v33, v33
    v_exp_f32 v34, v34
    v_exp_f32 v35, v35
    v_mul_f32 v16, v16, v38
    v_mul_f32 v17, v17, v38
    v_mul_f32 v18, v18, v38
    v_mul_f32 v19, v19, v38
    v_mul_f32 v20, v20, v38
    v_mul_f32 v21, v21, v38
    v_mul_f32 v22, v22, v38
    v_mul_f32 v23, v23, v38
    v_mul_f32 v24, v24, v39
    v_mul_f32 v25, v25, v39
    v_mul_f32 v26, v26, v39
    v_mul_f32 v27, v27, v39
    v_mul_f32 v28, v28, v39
    v_mul_f32 v29, v29, v39
    v_mul_f32 v30, v30, v39
    v_mul_f32 v31, v31, v39
    v_cvt_pk_bf16_f32 v36, v32, v33
    v_cvt_pk_bf16_f32 v37, v34, v35
    v_add_f32 v46, v32, v33
    v_add_f32 v47, v34, v35
    v_fma_f32 v13, v13, v38, v46
    v_fma_f32 v15, v15, v39, v47
    s_waitcnt vmcnt(8)
    v_perm_b32 v42, v164, v160, s60
    v_perm_b32 v43, v164, v160, s61
    v_perm_b32 v44, v165, v161, s60
    v_perm_b32 v45, v165, v161, s61
    v_dot2_f32_bf16 v16, v42, v36, v16
    v_dot2_f32_bf16 v17, v43, v36, v17
    v_dot2_f32_bf16 v18, v44, v36, v18
    v_dot2_f32_bf16 v19, v45, v36, v19
    v_perm_b32 v42, v166, v162, s60
    v_perm_b32 v43, v166, v162, s61
    v_perm_b32 v44, v167, v163, s60
    v_perm_b32 v45, v167, v163, s61
    v_dot2_f32_bf16 v20, v42, v36, v20
    v_dot2_f32_bf16 v21, v43, v36, v21
    v_dot2_f32_bf16 v22, v44, v36, v22
    v_dot2_f32_bf16 v23, v45, v36, v23
    v_perm_b32 v46, v172, v168, s60
    v_perm_b32 v47, v172, v168, s61
    v_perm_b32 v48, v173, v169, s60
    v_perm_b32 v49, v173, v169, s61
    v_dot2_f32_bf16 v24, v46, v37, v24
    v_dot2_f32_bf16 v25, v47, v37, v25
    v_dot2_f32_bf16 v26, v48, v37, v26
    v_dot2_f32_bf16 v27, v49, v37, v27
    v_perm_b32 v46, v174, v170, s60
    v_perm_b32 v47, v174, v170, s61
    v_perm_b32 v48, v175, v171, s60
    v_perm_b32 v49, v175, v171, s61
    v_dot2_f32_bf16 v28, v46, v37, v28
    v_dot2_f32_bf16 v29, v47, v37, v29
    v_dot2_f32_bf16 v30, v48, v37, v30
    v_dot2_f32_bf16 v31, v49, v37, v31
    s_waitcnt vmcnt(4)
    v_dot2_f32_bf16 v32, v144, v4, 0
    v_dot2_f32_bf16 v33, v148, v4, 0
    v_dot2_f32_bf16 v34, v152, v8, 0
    v_dot2_f32_bf16 v35, v156, v8, 0
    v_dot2_f32_bf16 v32, v145, v5, v32
    v_dot2_f32_bf16 v33, v149, v5, v33
    v_dot2_f32_bf16 v34, v153, v9, v34
    v_dot2_f32_bf16 v35, v157, v9, v35
    v_dot2_f32_bf16 v32, v146, v6, v32
    v_dot2_f32_bf16 v33, v150, v6, v33
    v_dot2_f32_bf16 v34, v154, v10, v34
    v_dot2_f32_bf16 v35, v158, v10, v35
    v_dot2_f32_bf16 v32, v147, v7, v32
    v_dot2_f32_bf16 v33, v151, v7, v33
    v_dot2_f32_bf16 v34, v155, v11, v34
    v_dot2_f32_bf16 v35, v159, v11, v35
    v_add_f32_dpp v32, v32, v32 row_ror:8 row_mask:0xf bank_mask:0xf
    v_add_f32_dpp v33, v33, v33 row_ror:8 row_mask:0xf bank_mask:0xf
    v_add_f32_dpp v34, v34, v34 row_ror:8 row_mask:0xf bank_mask:0xf
    v_add_f32_dpp v35, v35, v35 row_ror:8 row_mask:0xf bank_mask:0xf
    v_add_f32_dpp v32, v32, v32 row_ror:4 row_mask:0xf bank_mask:0xf
    v_add_f32_dpp v33, v33, v33 row_ror:4 row_mask:0xf bank_mask:0xf
    v_add_f32_dpp v34, v34, v34 row_ror:4 row_mask:0xf bank_mask:0xf
    v_add_f32_dpp v35, v35, v35 row_ror:4 row_mask:0xf bank_mask:0xf
    v_add_f32_dpp v32, v32, v32 row_ror:2 row_mask:0xf bank_mask:0xf
    v_add_f32_dpp v33, v33, v33 row_ror:2 row_mask:0xf bank_mask:0xf
    v_add_f32_dpp v34, v34, v34 row_ror:2 row_mask:0xf bank_mask:0xf
    v_add_f32_dpp v35, v35, v35 row_ror:2 row_mask:0xf bank_mask:0xf
    v_add_f32_dpp v32, v32, v32 row_ror:1 row_mask:0xf bank_mask:0xf
    v_add_f32_dpp v33, v33, v33 row_ror:1 row_mask:0xf bank_mask:0xf
    v_add_f32_dpp v34, v34, v34 row_ror:1 row_mask:0xf bank_mask:0xf
    v_add_f32_dpp v35, v35, v35 row_ror:1 row_mask:0xf bank_mask:0xf
    v_cvt_pk_bf16_f32 v42, v32, v33
    v_cvt_pk_bf16_f32 v43, v34, v35
    v_lshlrev_b32 v32, 16, v42
    v_and_b32 v33, 0xffff0000, v42
    v_lshlrev_b32 v34, 16, v43
    v_and_b32 v35, 0xffff0000, v43
    v_mul_f32 v32, s69, v32
    v_mul_f32 v33, s69, v33
    v_mul_f32 v34, s69, v34
    v_mul_f32 v35, s69, v35
    v_cvt_pk_bf16_f32 v42, v32, v33
    v_cvt_pk_bf16_f32 v43, v34, v35
    v_lshlrev_b32 v32, 16, v42
    v_and_b32 v33, 0xffff0000, v42
    s_branch L_tsk8
L_tch7:
    s_branch L_touch_ret
L_tsk8:
    v_lshlrev_b32 v34, 16, v43
    v_and_b32 v35, 0xffff0000, v43
    v_max3_f32 v46, v32, v33, v12
    v_max3_f32 v47, v34, v35, v14
    v_sub_f32 v48, v12, v46
    v_sub_f32 v49, v14, v47
    v_mul_f32 v40, s68, v46
    v_mul_f32 v41, s68, v47
    v_mul_f32 v48, s68, v48
    v_mul_f32 v49, s68, v49
    v_mov_b32 v12, v46
    v_mov_b32 v14, v47
    v_fma_f32 v32, v32, s68, -v40
    v_fma_f32 v33, v33, s68, -v40
    v_fma_f32 v34, v34, s68, -v41
    v_fma_f32 v35, v35, s68, -v41
    v_exp_f32 v38, v48
    v_exp_f32 v39, v49
    v_exp_f32 v32, v32
    v_exp_f32 v33, v33
    v_exp_f32 v34, v34
    v_exp_f32 v35, v35
    v_mul_f32 v16, v16, v38
    v_mul_f32 v17, v17, v38
    v_mul_f32 v18, v18, v38
    v_mul_f32 v19, v19, v38
    v_mul_f32 v20, v20, v38
    v_mul_f32 v21, v21, v38
    v_mul_f32 v22, v22, v38
    v_mul_f32 v23, v23, v38
    v_mul_f32 v24, v24, v39
    v_mul_f32 v25, v25, v39
    v_mul_f32 v26, v26, v39
    v_mul_f32 v27, v27, v39
    v_mul_f32 v28, v28, v39
    v_mul_f32 v29, v29, v39
    v_mul_f32 v30, v30, v39
    v_mul_f32 v31, v31, v39
    v_cvt_pk_bf16_f32 v36, v32, v33
    v_cvt_pk_bf16_f32 v37, v34, v35
    v_add_f32 v46, v32, v33
    v_add_f32 v47, v34, v35
    v_fma_f32 v13, v13, v38, v46
    v_fma_f32 v15, v15, v39, v47
    s_waitcnt vmcnt(0)
    v_perm_b32 v42, v180, v176, s60
    v_perm_b32 v43, v180, v176, s61
    v_perm_b32 v44, v181, v177, s60
    s_branch L_tsk9
L_tch8:
    s_branch L_touch_ret
L_tsk9:
    v_perm_b32 v45, v181, v177, s61
    v_dot2_f32_bf16 v16, v42, v36, v16
    v_dot2_f32_bf16 v17, v43, v36, v17
    v_dot2_f32_bf16 v18, v44, v36, v18
    v_dot2_f32_bf16 v19, v45, v36, v19
    v_perm_b32 v42, v182, v178, s60
    v_perm_b32 v43, v182, v178, s61
    v_perm_b32 v44, v183, v179, s60
    v_perm_b32 v45, v183, v179, s61
    v_dot2_f32_bf16 v20, v42, v36, v20
    v_dot2_f32_bf16 v21, v43, v36, v21
    v_dot2_f32_bf16 v22, v44, v36, v22
    v_dot2_f32_bf16 v23, v45, v36, v23
    v_perm_b32 v46, v188, v184, s60
    v_perm_b32 v47, v188, v184, s61
    v_perm_b32 v48, v189, v185, s60
    v_perm_b32 v49, v189, v185, s61
    v_dot2_f32_bf16 v24, v46, v37, v24
    v_dot2_f32_bf16 v25, v47, v37, v25
    v_dot2_f32_bf16 v26, v48, v37, v26
    v_dot2_f32_bf16 v27, v49, v37, v27
    v_perm_b32 v46, v190, v186, s60
    v_perm_b32 v47, v190, v186, s61
    v_perm_b32 v48, v191, v187, s60
    v_perm_b32 v49, v191, v187, s61
    v_dot2_f32_bf16 v28, v46, v37, v28
    v_dot2_f32_bf16 v29, v47, v37, v29
    v_dot2_f32_bf16 v30, v48, v37, v30
    v_dot2_f32_bf16 v31, v49, v37, v31
    s_branch L_loop_done
L_drain1:
    v_add_f32_dpp v32, v32, v32 row_ror:8 row_mask:0xf bank_mask:0xf
    v_add_f32_dpp v33, v33, v33 row_ror:8 row_mask:0xf bank_mask:0xf
    v_add_f32_dpp v34, v34, v34 row_ror:8 row_mask:0xf bank_mask:0xf
    v_add_f32_dpp v35, v35, v35 row_ror:8 row_mask:0xf bank_mask:0xf
    v_add_f32_dpp v32, v32, v32 row_ror:4 row_mask:0xf bank_mask:0xf
    v_add_f32_dpp v33, v33, v33 row_ror:4 row_mask:0xf bank_mask:0xf
    v_add_f32_dpp v34, v34, v34 row_ror:4 row_mask:0xf bank_mask:0xf
    v_add_f32_dpp v35, v35, v35 row_ror:4 row_mask:0xf bank_mask:0xf
    v_add_f32_dpp v32, v32, v32 row_ror:2 row_mask:0xf bank_mask:0xf
    v_add_f32_dpp v33, v33, v33 row_ror:2 row_mask:0xf bank_mask:0xf
    v_add_f32_dpp v34, v34, v34 row_ror:2 row_mask:0xf bank_mask:0xf
    v_add_f32_dpp v35, v35, v35 row_ror:2 row_mask:0xf bank_mask:0xf
    v_add_f32_dpp v32, v32, v32 row_ror:1 row_mask:0xf bank_mask:0xf
    v_add_f32_dpp v33, v33, v33 row_ror:1 row_mask:0xf bank_mask:0xf
    v_add_f32_dpp v34, v34, v34 row_ror:1 row_mask:0xf bank_mask:0xf
    v_add_f32_dpp v35, v35, v35 row_ror:1 row_mask:0xf bank_mask:0xf
    v_cvt_pk_bf16_f32 v42, v32, v33
    v_cvt_pk_bf16_f32 v43, v34, v35
    v_lshlrev_b32 v32, 16, v42
    v_and_b32 v33, 0xffff0000, v42
    v_lshlrev_b32 v34, 16, v43
    v_and_b32 v35, 0xffff0000, v43
    v_mul_f32 v32, s69, v32
    v_mul_f32 v33, s69, v33
    v_mul_f32 v34, s69, v34
    v_mul_f32 v35, s69, v35
    v_cvt_pk_bf16_f32 v42, v32, v33
    v_cvt_pk_bf16_f32 v43, v34, v35
    v_lshlrev_b32 v32, 16, v42
    v_and_b32 v33, 0xffff0000, v42
    v_lshlrev_b32 v34, 16, v43
    v_and_b32 v35, 0xffff0000, v43
    v_max3_f32 v46, v32, v33, v12
    v_max3_f32 v47, v34, v35, v14
    v_sub_f32 v48, v12, v46
    v_sub_f32 v49, v14, v47
    v_mul_f32 v40, s68, v46
    v_mul_f32 v41, s68, v47
    v_mul_f32 v48, s68, v48
    v_mul_f32 v49, s68, v49
    v_mov_b32 v12, v46
    v_mov_b32 v14, v47
    v_fma_f32 v32, v32, s68, -v40
    v_fma_f32 v33, v33, s68, -v40
    v_fma_f32 v34, v34, s68, -v41
    v_fma_f32 v35, v35, s68, -v41
    v_exp_f32 v38, v48
    v_exp_f32 v39, v49
    v_exp_f32 v32, v32
    v_exp_f32 v33, v33
    v_exp_f32 v34, v34
    v_exp_f32 v35, v35
    v_mul_f32 v16, v16, v38
    v_mul_f32 v17, v17, v38
    v_mul_f32 v18, v18, v38
    v_mul_f32 v19, v19, v38
    v_mul_f32 v20, v20, v38
    v_mul_f32 v21, v21, v38
    v_mul_f32 v22, v22, v38
    v_mul_f32 v23, v23, v38
    v_mul_f32 v24, v24, v39
    v_mul_f32 v25, v25, v39
    v_mul_f32 v26, v26, v39
    v_mul_f32 v27, v27, v39
    v_mul_f32 v28, v28, v39
    v_mul_f32 v29, v29, v39
    v_mul_f32 v30, v30, v39
    v_mul_f32 v31, v31, v39
    v_cvt_pk_bf16_f32 v36, v32, v33
    v_cvt_pk_bf16_f32 v37, v34, v35
    v_add_f32 v46, v32, v33
    v_add_f32 v47, v34, v35
    v_fma_f32 v13, v13, v38, v46
    v_fma_f32 v15, v15, v39, v47
    s_waitcnt vmcnt(8)
    v_perm_b32 v42, v180, v176, s60
    v_perm_b32 v43, v180, v176, s61
    v_perm_b32 v44, v181, v177, s60
    v_perm_b32 v45, v181, v177, s61
    v_dot2_f32_bf16 v16, v42, v36, v16
    v_dot2_f32_bf16 v17, v43, v36, v17
    v_dot2_f32_bf16 v18, v44, v36, v18
    v_dot2_f32_bf16 v19, v45, v36, v19
    v_perm_b32 v42, v182, v178, s60
    v_perm_b32 v43, v182, v178, s61
    v_perm_b32 v44, v183, v179, s60
    v_perm_b32 v45, v183, v179, s61
    v_dot2_f32_bf16 v20, v42, v36, v20
    v_dot2_f32_bf16 v21, v43, v36, v21
    v_dot2_f32_bf16 v22, v44, v36, v22
    v_dot2_f32_bf16 v23, v45, v36, v23
    v_perm_b32 v46, v188, v184, s60
    v_perm_b32 v47, v188, v184, s61
    v_perm_b32 v48, v189, v185, s60
    v_perm_b32 v49, v189, v185, s61
    v_dot2_f32_bf16 v24, v46, v37, v24
    v_dot2_f32_bf16 v25, v47, v37, v25
    v_dot2_f32_bf16 v26, v48, v37, v26
    v_dot2_f32_bf16 v27, v49, v37, v27
    v_perm_b32 v46, v190, v186, s60
    v_perm_b32 v47, v190, v186, s61
    v_perm_b32 v48, v191, v187, s60
    v_perm_b32 v49, v191, v187, s61
    v_dot2_f32_bf16 v28, v46, v37, v28
    v_dot2_f32_bf16 v29, v47, v37, v29
    v_dot2_f32_bf16 v30, v48, v37, v30
    v_dot2_f32_bf16 v31, v49, v37, v31
    s_waitcnt vmcnt(4)
    v_dot2_f32_bf16 v32, v128, v4, 0
    v_dot2_f32_bf16 v33, v132, v4, 0
    v_dot2_f32_bf16 v34, v136, v8, 0
    v_dot2_f32_bf16 v35, v140, v8, 0
    v_dot2_f32_bf16 v32, v129, v5, v32
    v_dot2_f32_bf16 v33, v133, v5, v33
    v_dot2_f32_bf16 v34, v137, v9, v34
    v_dot2_f32_bf16 v35, v141, v9, v35
    v_dot2_f32_bf16 v32, v130, v6, v32
    v_dot2_f32_bf16 v33, v134, v6, v33
    v_dot2_f32_bf16 v34, v138, v10, v34
    v_dot2_f32_bf16 v35, v142, v10, v35
    v_dot2_f32_bf16 v32, v131, v7, v32
    v_dot2_f32_bf16 v33, v135, v7, v33
    v_dot2_f32_bf16 v34, v139, v11, v34
    v_dot2_f32_bf16 v35, v143, v11, v35
    v_add_f32_dpp v32, v32, v32 row_ror:8 row_mask:0xf bank_mask:0xf
    v_add_f32_dpp v33, v33, v33 row_ror:8 row_mask:0xf bank_mask:0xf
    s_branch L_tsk10
L_tch9:
    s_branch L_touch_ret
L_tsk10:
    v_add_f32_dpp v34, v34, v34 row_ror:8 row_mask:0xf bank_mask:0xf
    v_add_f32_dpp v35, v35, v35 row_ror:8 row_mask:0xf bank_mask:0xf
    v_add_f32_dpp v32, v32, v32 row_ror:4 row_mask:0xf bank_mask:0xf
    v_add_f32_dpp v33, v33, v33 row_ror:4 row_mask:0xf bank_mask:0xf
    v_add_f32_dpp v34, v34, v34 row_ror:4 row_mask:0xf bank_mask:0xf
    v_add_f32_dpp v35, v35, v35 row_ror:4 row_mask:0xf bank_mask:0xf
    v_add_f32_dpp v32, v32, v32 row_ror:2 row_mask:0xf bank_mask:0xf
    v_add_f32_dpp v33, v33, v33 row_ror:2 row_mask:0xf bank_mask:0xf
    v_add_f32_dpp v34, v34, v34 row_ror:2 row_mask:0xf bank_mask:0xf
    v_add_f32_dpp v35, v35, v35 row_ror:2 row_mask:0xf bank_mask:0xf
    v_add_f32_dpp v32, v32, v32 row_ror:1 row_mask:0xf bank_mask:0xf
    v_add_f32_dpp v33, v33, v33 row_ror:1 row_mask:0xf bank_mask:0xf
    v_add_f32_dpp v34, v34, v34 row_ror:1 row_mask:0xf bank_mask:0xf
    v_add_f32_dpp v35, v35, v35 row_ror:1 row_mask:0xf bank_mask:0xf
    v_cvt_pk_bf16_f32 v42, v32, v33
    v_cvt_pk_bf16_f32 v43, v34, v35
    v_lshlrev_b32 v32, 16, v42
    v_and_b32 v33, 0xffff0000, v42
    v_lshlrev_b32 v34, 16, v43
    v_and_b32 v35, 0xffff0000, v43
    v_mul_f32 v32, s69, v32
    v_mul_f32 v33, s69, v33
    v_mul_f32 v34, s69, v34
    v_mul_f32 v35, s69, v35
    v_cvt_pk_bf16_f32 v42, v32, v33
    v_cvt_pk_bf16_f32 v43, v34, v35
    v_lshlrev_b32 v32, 16, v42
    v_and_b32 v33, 0xffff0000, v42
    v_lshlrev_b32 v34, 16, v43
    v_and_b32 v35, 0xffff0000, v43
    v_max3_f32 v46, v32, v33, v12
    v_max3_f32 v47, v34, v35, v14
    v_sub_f32 v48, v12, v46
    v_sub_f32 v49, v14, v47
    v_mul_f32 v40, s68, v46
    v_mul_f32 v41, s68, v47
    v_mul_f32 v48, s68, v48
    v_mul_f32 v49, s68, v49
    v_mov_b32 v12, v46
    v_mov_b32 v14, v47
    v_fma_f32 v32, v32, s68, -v40
    v_fma_f32 v33, v33, s68, -v40
    v_fma_f32 v34, v34, s68, -v41
    v_fma_f32 v35, v35, s68, -v41
    v_exp_f32 v38, v48
    v_exp_f32 v39, v49
    v_exp_f32 v32, v32
    v_exp_f32 v33, v33
    v_exp_f32 v34, v34
    v_exp_f32 v35, v35
    v_mul_f32 v16, v16, v38
    v_mul_f32 v17, v17, v38
    v_mul_f32 v18, v18, v38
    v_mul_f32 v19, v19, v38
    v_mul_f32 v20, v20, v38
    v_mul_f32 v21, v21, v38
    v_mul_f32 v22, v22, v38
    v_mul_f32 v23, v23, v38
    v_mul_f32 v24, v24, v39
    v_mul_f32 v25, v25, v39
    v_mul_f32 v26, v26, v39
    v_mul_f32 v27, v27, v39
    v_mul_f32 v28, v28, v39
    v_mul_f32 v29, v29, v39
    v_mul_f32 v30, v30, v39
    v_mul_f32 v31, v31, v39
    v_cvt_pk_bf16_f32 v36, v32, v33
    v_cvt_pk_bf16_f32 v37, v34, v35
    v_add_f32 v46, v32, v33
    v_add_f32 v47, v34, v35
    v_fma_f32 v13, v13, v38, v46
    v_fma_f32 v15, v15, v39, v47
    s_waitcnt vmcnt(0)
    v_perm_b32 v42, v164, v160, s60
    v_perm_b32 v43, v164, v160, s61
    v_perm_b32 v44, v165, v161, s60
    v_perm_b32 v45, v165, v161, s61
    v_dot2_f32_bf16 v16, v42, v36, v16
    v_dot2_f32_bf16 v17, v43, v36, v17
    v_dot2_f32_bf16 v18, v44, v36, v18
    v_dot2_f32_bf16 v19, v45, v36, v19
    v_perm_b32 v42, v166, v162, s60
    v_perm_b32 v43, v166, v162, s61
    v_perm_b32 v44, v167, v163, s60
    v_perm_b32 v45, v167, v163, s61
    v_dot2_f32_bf16 v20, v42, v36, v20
    v_dot2_f32_bf16 v21, v43, v36, v21
    v_dot2_f32_bf16 v22, v44, v36, v22
    v_dot2_f32_bf16 v23, v45, v36, v23
    v_perm_b32 v46, v172, v168, s60
    v_perm_b32 v47, v172, v168, s61
    v_perm_b32 v48, v173, v169, s60
    v_perm_b32 v49, v173, v169, s61
    v_dot2_f32_bf16 v24, v46, v37, v24
    v_dot2_f32_bf16 v25, v47, v37, v25
    v_dot2_f32_bf16 v26, v48, v37, v26
    v_dot2_f32_bf16 v27, v49, v37, v27
    v_perm_b32 v46, v174, v170, s60
    v_perm_b32 v47, v174, v170, s61
    v_perm_b32 v48, v175, v171, s60
    v_perm_b32 v49, v175, v171, s61
    v_dot2_f32_bf16 v28, v46, v37, v28
    v_dot2_f32_bf16 v29, v47, v37, v29
    v_dot2_f32_bf16 v30, v48, v37, v30
    v_dot2_f32_bf16 v31, v49, v37, v31
L_loop_done:
    s_waitcnt vmcnt(0)
    v_mov_b32 v42, v12
    v_mov_b32 v43, v14
    v_mov_b32 v44, v42
    v_mov_b32 v45, v43
    s_nop 0
    v_permlane16_swap_b32 v42, v44
    v_permlane16_swap_b32 v43, v45
    v_max_f32 v42, v42, v44
    v_max_f32 v43, v43, v45
    v_mov_b32 v44, v42
    v_mov_b32 v45, v43
    s_nop 0
    v_permlane32_swap_b32 v42, v44
    v_permlane32_swap_b32 v43, v45
    v_max_f32 v42, v42, v44
    v_max_f32 v43, v43, v45
    v_sub_f32 v44, v12, v42
    v_sub_f32 v45, v14, v43
    v_mul_f32 v44, s68, v44
    v_mul_f32 v45, s68, v45
    v_exp_f32 v44, v44
    v_exp_f32 v45, v45
    v_and_b32 v48, 15, v3
    v_lshrrev_b32 v49, 4, v3
    v_lshlrev_b32 v48, 5, v48
    v_lshl_add_u32 v49, v49, 2, v48
    s_lshl_b32 s4, s3, 9
    v_add_u32 v49, s4, v49
    s_lshl_b32 s4, s3, 2
    v_mov_b32 v50, s4
    v_mul_f32 v16, v16, v44
    v_mul_f32 v17, v17, v44
    v_mul_f32 v18, v18, v44
    v_mul_f32 v19, v19, v44
    v_mul_f32 v20, v20, v44
    v_mul_f32 v21, v21, v44
    v_mul_f32 v22, v22, v44
    v_mul_f32 v23, v23, v44
    v_mul_f32 v13, v13, v44
    v_mul_f32 v24, v24, v45
    v_mul_f32 v25, v25, v45
    v_mul_f32 v26, v26, v45
    v_mul_f32 v27, v27, v45
    v_mul_f32 v28, v28, v45
    v_mul_f32 v29, v29, v45
    v_mul_f32 v30, v30, v45
    v_mul_f32 v31, v31, v45
    v_mul_f32 v15, v15, v45
    v_permlane16_swap_b32 v16, v17
    v_permlane16_swap_b32 v18, v19
    v_permlane16_swap_b32 v20, v21
    v_permlane16_swap_b32 v22, v23
    v_permlane16_swap_b32 v24, v25
    v_permlane16_swap_b32 v26, v27
    v_permlane16_swap_b32 v28, v29
    v_permlane16_swap_b32 v30, v31
    v_add_f32 v16, v16, v17
    v_add_f32 v18, v18, v19
    v_add_f32 v20, v20, v21
    v_add_f32 v22, v22, v23
    v_add_f32 v24, v24, v25
    v_add_f32 v26, v26, v27
    v_add_f32 v28, v28, v29
    v_add_f32 v30, v30, v31
    v_permlane32_swap_b32 v16, v18
    v_permlane32_swap_b32 v20, v22
    v_permlane32_swap_b32 v24, v26
    v_permlane32_swap_b32 v28, v30
    v_add_f32 v16, v16, v18
    v_add_f32 v20, v20, v22
    v_add_f32 v24, v24, v26
    v_add_f32 v28, v28, v30
    v_mov_b32 v46, v13
    v_mov_b32 v47, v15
    s_nop 0
    v_permlane16_swap_b32 v13, v46
    v_permlane16_swap_b32 v15, v47
    v_add_f32 v13, v13, v46
    v_add_f32 v15, v15, v47
    v_mov_b32 v46, v13
    v_mov_b32 v47, v15
    s_nop 0
    v_permlane32_swap_b32 v13, v46
    v_permlane32_swap_b32 v15, v47
    v_add_f32 v13, v13, v46
    v_add_f32 v15, v15, v47
    v_add_u32 v51, 1024, v49
    v_add_u32 v52, 5120, v49
    ds_write2_b32 v51, v16, v20 offset0:0 offset1:4
    ds_write2_b32 v52, v24, v28 offset0:0 offset1:4
    s_mov_b64 exec, 1
    ds_write_b32 v50, v42 offset:576
    ds_write_b32 v50, v13 offset:608
    s_branch L_tsk11
L_tch10:
    s_branch L_tch6
L_tsk11:
    ds_write_b32 v50, v43 offset:640
    ds_write_b32 v50, v15 offset:672
    s_mov_b64 exec, -1
    s_waitcnt lgkmcnt(0)
    s_barrier
    s_cmp_ge_u32 s3, 2
    s_cbranch_scc1 L_attn_done
    v_and_b32 v56, 31, v3
    v_lshrrev_b32 v57, 5, v3
    v_lshlrev_b32 v56, 4, v56
    v_lshl_add_u32 v36, v57, 11, v56
    s_lshl_b32 s4, s3, 12
    v_add_u32 v36, s4, v36
    ds_read_b128 v[4:7], v36 offset:1024
    ds_read_b128 v[8:11], v36 offset:1536
    ds_read_b128 v[12:15], v36 offset:2048
    ds_read_b128 v[16:19], v36 offset:2560
    s_lshl_b32 s4, s3, 6
    v_mov_b32 v37, s4
    ds_read_b128 v[20:23], v37 offset:576
    ds_read_b128 v[24:27], v37 offset:592
    v_lshl_add_u32 v38, v57, 4, v37
    ds_read_b128 v[28:31], v38 offset:608
    ds_read_b128 v[32:35], v38 offset:576
    s_lshl_b32 s4, s57, 3
    s_add_u32 s4, s4, s58
    s_lshl_b32 s5, s4, 10
    s_lshl_b32 s6, s3, 9
    s_add_u32 s5, s5, s6
    v_add_u32 v56, s5, v56
    s_lshl_b32 s4, s57, 8
    s_lshl_b32 s6, s3, 7
    s_add_u32 s4, s4, s6
    s_lshl_b32 s6, s58, 4
    s_add_u32 s4, s4, s6
    s_add_u32 s4, s4, 0x40000
    v_mov_b32 v57, s4
    v_cmp_le_u32 vcc, 32, v3
    s_nop 1
    v_cndmask_b32 v56, v56, v57, vcc
    s_waitcnt lgkmcnt(0)
    v_max3_f32 v36, v20, v21, v22
    v_max3_f32 v37, v23, v24, v25
    v_max3_f32 v36, v36, v26, v27
    v_max_f32 v36, v36, v37
    v_sub_f32 v38, v32, v36
    v_sub_f32 v39, v33, v36
    v_sub_f32 v40, v34, v36
    v_sub_f32 v41, v35, v36
    v_mul_f32 v38, s68, v38
    v_mul_f32 v39, s68, v39
    v_mul_f32 v40, s68, v40
    v_mul_f32 v41, s68, v41
    v_exp_f32 v38, v38
    v_exp_f32 v39, v39
    v_exp_f32 v40, v40
    v_exp_f32 v41, v41
    v_mul_f32 v44, v4, v38
    v_mul_f32 v45, v5, v38
    v_mul_f32 v46, v6, v38
    v_mul_f32 v47, v7, v38
    v_mul_f32 v48, v28, v38
    v_fmac_f32 v44, v8, v39
    v_fmac_f32 v45, v9, v39
    v_fmac_f32 v46, v10, v39
    v_fmac_f32 v47, v11, v39
    v_fmac_f32 v48, v29, v39
    v_fmac_f32 v44, v12, v40
    v_fmac_f32 v45, v13, v40
    v_fmac_f32 v46, v14, v40
    v_fmac_f32 v47, v15, v40
    v_fmac_f32 v48, v30, v40
    v_fmac_f32 v44, v16, v41
    v_fmac_f32 v45, v17, v41
    v_fmac_f32 v46, v18, v41
    v_fmac_f32 v47, v19, v41
    v_fmac_f32 v48, v31, v41
    v_mov_b32 v50, v44
    v_mov_b32 v51, v45
    v_mov_b32 v52, v46
    v_mov_b32 v53, v47
    v_mov_b32 v54, v48
    v_permlane32_swap_b32 v44, v50
    v_permlane32_swap_b32 v45, v51
    v_permlane32_swap_b32 v46, v52
    v_permlane32_swap_b32 v47, v53
    v_permlane32_swap_b32 v48, v54
    v_add_f32 v44, v44, v50
    v_add_f32 v45, v45, v51
    v_add_f32 v46, v46, v52
    v_add_f32 v47, v47, v53
    v_add_f32 v48, v48, v54
    v_cndmask_b32 v44, v44, v36, vcc
    v_cndmask_b32 v45, v45, v48, vcc
    v_cndmask_b32 v46, v46, v58, vcc
    v_perm_b32 v44, v44, v58, s62
    v_perm_b32 v47, v47, v58, s63
    s_mov_b32 exec_hi, 1
    global_store_dwordx4 v56, v[44:47], s[70:71] sc1
    s_mov_b64 exec, -1
L_attn_done:
    s_cmp_eq_u32 s79, 255
    s_cbranch_scc1 L_fin
    ds_read_b32 v59, v62 offset:516
    s_and_b32 s99, s59, 0xffff
    v_and_b32 v52, 7, v3
    v_lshlrev_b32 v60, 5, v52
    v_lshrrev_b32 v53, 4, v3
    v_lshl_add_u32 v60, v53, 8, v60
    s_lshl_b32 s4, s3, 9
    v_add_u32 v60, s4, v60
    v_and_b32 v54, 1, v3
    v_lshlrev_b32 v61, 6, v54
    v_bfe_u32 v55, v3, 2, 1
    v_lshl_add_u32 v61, v55, 10, v61
    v_lshl_add_u32 v61, v53, 4, v61
    s_and_b32 s4, s3, 3
    s_lshl_b32 s4, s4, 8
    v_add_u32 v61, s4, v61
    s_cmp_lt_u32 s3, 4
    s_cbranch_scc1 L_pt_low
    v_lshlrev_b32 v63, 4, v54
    v_bfe_u32 v52, v3, 1, 1
    v_lshl_add_u32 v63, v52, 7, v63
    v_lshl_add_u32 v63, v55, 8, v63
    v_bfe_u32 v52, v3, 3, 1
    v_lshl_add_u32 v63, v52, 11, v63
    v_lshl_add_u32 v63, v53, 5, v63
    v_lshlrev_b32 v0, 11, v53
    v_and_b32 v52, 15, v3
    v_lshl_add_u32 v0, v52, 5, v0
    s_lshl_b32 s4, s79, 12
    s_and_b32 s5, s3, 3
    s_lshl_b32 s5, s5, 9
    s_add_u32 s4, s4, s5
    v_add_u32 v0, s4, v0
    v_bfe_u32 v52, v3, 4, 1
    v_and_b32 v54, 15, v3
    v_lshlrev_b32 v52, 11, v52
    v_lshl_add_u32 v52, v54, 4, v52
    s_lshr_b32 s4, s79, 3
    s_lshl_b32 s4, s4, 12
    s_and_b32 s5, s79, 7
    s_lshl_b32 s5, s5, 8
    s_add_u32 s4, s4, s5
    v_add_u32 v2, s4, v52
    s_branch L_pt_done
L_tch11:
    s_branch L_tch7
L_pt_low:
    s_and_b32 s6, s3, 1
    s_lshr_b32 s7, s3, 1
    s_lshl_b32 s4, s6, 10
    s_lshl_b32 s5, s7, 9
    s_add_u32 s4, s4, s5
    v_lshlrev_b32 v136, 3, v3
    v_add_u32 v136, s4, v136
    global_load_dwordx2 v[56:57], v136, s[16:17]
    s_lshl_b32 s4, s4, 1
    s_add_u32 s4, s4, 4096
    v_add_u32 v134, s4, v1
    v_add_u32 v135, 8192, v134
    s_lshl_b32 s4, s6, 10
    v_add_u32 v141, s4, v1
    s_lshl_b32 s4, s6, 3
    v_mov_b32 v142, s4
    s_lshl_b32 s8, s79, 1
    s_add_u32 s8, s8, s6
    s_bfe_u32 s9, s8, 0x10004
    s_and_b32 s8, s8, 15
    v_lshrrev_b32 v52, 3, v3
    v_and_b32 v53, 7, v3
    v_lshlrev_b32 v54, 4, v53
    s_lshl_b32 s4, s9, 11
    s_lshl_b32 s5, s8, 7
    s_add_u32 s4, s4, s5
    v_add_u32 v54, s4, v54
    v_lshl_add_u32 v137, v52, 12, v54
    v_add_u32 v138, 0x8000, v137
    v_add_u32 v55, 16, v52
    v_min_u32 v55, 21, v55
    v_lshl_add_u32 v139, v55, 12, v54
    s_lshl_b32 s4, s9, 10
    s_lshl_b32 s5, s8, 6
    s_add_u32 s4, s4, s5
    v_lshrrev_b32 v52, 4, v3
    v_lshl_add_u32 v52, v53, 2, v52
    v_lshlrev_b32 v140, 1, v52
    v_add_u32 v140, s4, v140
    s_waitcnt vmcnt(0)
    v_lshlrev_b32 v128, 16, v56
    v_and_b32 v129, 0xffff0000, v56
    v_lshlrev_b32 v130, 16, v57
    v_and_b32 v131, 0xffff0000, v57
L_pt_done:
    s_waitcnt lgkmcnt(0)
    v_readfirstlane_b32 s15, v59
    s_cmp_eq_u32 s15, 0
    s_cbranch_scc1 L_nopre
    s_cmp_lt_u32 s3, 4
    s_cbranch_scc1 L_nopre
    v_not_b32 v52, v58
    v_not_b32 v53, v58
    v_not_b32 v54, v58
    v_not_b32 v55, v58
    s_mov_b32 exec_hi, 0
    s_cmp_lg_u32 s3, 4
    s_cbranch_scc1 L_nopre_y
    global_store_dwordx4 v2, v[52:55], s[72:73]
L_nopre_y:
    s_cmp_ge_u32 s79, 22
    s_cbranch_scc1 L_nopre_z
    global_store_dwordx4 v0, v[52:55], s[74:75]
    global_store_dwordx4 v0, v[52:55], s[74:75] offset:16
L_nopre_z:
    s_mov_b64 exec, -1
L_nopre:
    s_cmp_ge_u32 s79, 22
    s_cbranch_scc1 L_nocs
    v_mov_b32 v44, 0x3f803f80
    v_mov_b32 v45, 0x3f803f80
    v_mov_b32 v46, 0x3f803f80
    v_mov_b32 v47, 0x3f803f80
    s_nop 1
    v_mfma_f32_16x16x32_bf16 v[4:7], v[44:47], v[192:195], 0
    v_mfma_f32_16x16x32_bf16 v[8:11], v[44:47], v[196:199], 0
    v_mfma_f32_16x16x32_bf16 v[12:15], v[44:47], v[200:203], 0
    v_mfma_f32_16x16x32_bf16 v[16:19], v[44:47], v[204:207], 0
    v_mfma_f32_16x16x32_bf16 v[20:23], v[44:47], v[208:211], 0
    v_mfma_f32_16x16x32_bf16 v[24:27], v[44:47], v[212:215], 0
    v_mfma_f32_16x16x32_bf16 v[28:31], v[44:47], v[216:219], 0
    v_mfma_f32_16x16x32_bf16 v[32:35], v[44:47], v[220:223], 0
    v_mfma_f32_16x16x32_bf16 v[4:7], v[44:47], v[224:227], v[4:7]
    v_mfma_f32_16x16x32_bf16 v[8:11], v[44:47], v[228:231], v[8:11]
    v_mfma_f32_16x16x32_bf16 v[12:15], v[44:47], v[232:235], v[12:15]
    v_mfma_f32_16x16x32_bf16 v[16:19], v[44:47], v[236:239], v[16:19]
    v_mfma_f32_16x16x32_bf16 v[20:23], v[44:47], v[240:243], v[20:23]
    v_mfma_f32_16x16x32_bf16 v[24:27], v[44:47], v[244:247], v[24:27]
    v_mfma_f32_16x16x32_bf16 v[28:31], v[44:47], v[248:251], v[28:31]
    v_mfma_f32_16x16x32_bf16 v[32:35], v[44:47], v[252:255], v[32:35]
    s_mov_b32 s76, 0x00ff00ff
    s_mov_b32 s77, 0
    v_add_f32_dpp v36, v5, v4 row_ror:8 row_mask:0xf bank_mask:0xf
    v_add_f32_dpp v37, v9, v8 row_ror:8 row_mask:0xf bank_mask:0xf
    v_add_f32_dpp v38, v13, v12 row_ror:8 row_mask:0xf bank_mask:0xf
    v_add_f32_dpp v39, v17, v16 row_ror:8 row_mask:0xf bank_mask:0xf
    v_add_f32_dpp v40, v21, v20 row_ror:8 row_mask:0xf bank_mask:0xf
    v_add_f32_dpp v41, v25, v24 row_ror:8 row_mask:0xf bank_mask:0xf
    v_add_f32_dpp v42, v29, v28 row_ror:8 row_mask:0xf bank_mask:0xf
    v_add_f32_dpp v43, v33, v32 row_ror:8 row_mask:0xf bank_mask:0xf
    s_mov_b64 exec, s[76:77]
    ds_write_b128 v60, v[36:39] offset:17408
    ds_write_b128 v60, v[40:43] offset:17424
    s_mov_b64 exec, -1
    s_waitcnt lgkmcnt(0)
    s_barrier
    s_cmp_lt_u32 s3, 4
    s_cbranch_scc1 L_cs_low
    ds_read_b128 v[4:7], v63 offset:17408
    ds_read_b128 v[8:11], v63 offset:17920
    ds_read_b128 v[12:15], v63 offset:18432
    ds_read_b128 v[16:19], v63 offset:18944
    s_waitcnt lgkmcnt(0)
    v_add_f32 v4, v4, v8
    v_add_f32 v12, v12, v16
    v_add_f32 v5, v5, v9
    v_add_f32 v13, v13, v17
    v_add_f32 v6, v6, v10
    v_add_f32 v14, v14, v18
    v_add_f32 v7, v7, v11
    v_add_f32 v15, v15, v19
    v_add_f32 v4, v4, v12
    v_add_f32 v5, v5, v13
    v_add_f32 v6, v6, v14
    v_add_f32 v7, v7, v15
    ds_write_b128 v63, v[4:7] offset:25600
    s_waitcnt lgkmcnt(0)
    s_branch L_nocs
L_tch12:
    s_branch L_tch8
L_cs_low:
    global_load_dwordx4 v[4:7], v134, s[72:73] offset:-4096
    global_load_dwordx4 v[8:11], v134, s[72:73] offset:0
    global_load_dwordx4 v[12:15], v135, s[72:73] offset:-4096
    global_load_dwordx4 v[16:19], v135, s[72:73] offset:0
    global_load_dwordx4 v[20:23], v137, s[74:75]
    global_load_dwordx4 v[24:27], v138, s[74:75]
    global_load_dwordx4 v[28:31], v139, s[74:75]
    global_load_dword v32, v140, s[34:35]
    global_load_dword v33, v62, s[38:39]
    s_waitcnt vmcnt(0)
L_nocs:
    v_add_u32 v56, 4096, v1
    v_and_b32 v52, 7, v3
    v_lshrrev_b32 v53, 5, v3
    v_lshlrev_b32 v53, 7, v53
    v_lshl_add_u32 v57, v52, 4, v53
    s_lshl_b32 s4, s3, 9
    v_lshlrev_b32 v59, 3, v3
    v_add_u32 v59, s4, v59
    v_and_b32 v52, 1, v3
    v_lshlrev_b32 v55, 6, v52
    v_bfe_u32 v52, v3, 2, 1
    v_lshl_add_u32 v55, v52, 8, v55
    v_lshrrev_b32 v52, 4, v3
    v_lshl_add_u32 v55, v52, 4, v55
    v_add_u32 v55, s4, v55
    s_lshr_b32 s4, s79, 3
    s_lshl_b32 s4, s4, 3
    s_add_u32 s4, s4, s3
    s_lshl_b32 s5, s4, 13
    s_add_u32 s6, s70, s5
    s_addc_u32 s7, s71, 0
    s_lshl_b32 s5, s4, 8
    s_add_u32 s5, s5, 0x40000
    s_add_u32 s8, s70, s5
    s_addc_u32 s9, s71, 0
    s_mov_b32 s78, 0
    global_load_dwordx4 v[4:7], v1, s[6:7] offset:0
    global_load_dwordx4 v[8:11], v1, s[6:7] offset:1024
    global_load_dwordx4 v[12:15], v1, s[6:7] offset:2048
    global_load_dwordx4 v[16:19], v1, s[6:7] offset:3072
    global_load_dwordx4 v[20:23], v56, s[6:7] offset:0
    global_load_dwordx4 v[24:27], v56, s[6:7] offset:1024
    global_load_dwordx4 v[28:31], v56, s[6:7] offset:2048
    global_load_dwordx4 v[32:35], v56, s[6:7] offset:3072
    global_load_dwordx4 v[36:39], v57, s[8:9] sc1
L_pchk0_O:
    s_waitcnt vmcnt(0)
    v_perm_b32 v40, v7, v4, s66
    v_perm_b32 v41, v11, v8, s66
    v_perm_b32 v42, v15, v12, s66
    v_perm_b32 v43, v19, v16, s66
    v_perm_b32 v44, v23, v20, s66
    v_perm_b32 v45, v27, v24, s66
    v_perm_b32 v46, v31, v28, s66
    v_perm_b32 v47, v35, v32, s66
    v_perm_b32 v48, v39, v36, s66
    v_xor_b32 v48, s99, v48
    v_bitop3_b32 v48, v48, v38, v58 bitop3:0xf6
    v_bitop3_b32 v52, v48, v40, s99 bitop3:0xf6
    v_bitop3_b32 v52, v52, v41, s99 bitop3:0xf6
    v_bitop3_b32 v52, v52, v42, s99 bitop3:0xf6
    v_bitop3_b32 v52, v52, v43, s99 bitop3:0xf6
    v_bitop3_b32 v52, v52, v44, s99 bitop3:0xf6
    v_bitop3_b32 v52, v52, v45, s99 bitop3:0xf6
    v_bitop3_b32 v52, v52, v46, s99 bitop3:0xf6
    v_bitop3_b32 v52, v52, v47, s99 bitop3:0xf6
    v_cmp_ne_u32 vcc, 0, v52
    s_cbranch_vccz L_pollok_O
    v_cmp_ne_u32_e64 s[18:19], s99, v40
    v_cmp_ne_u32_e64 s[20:21], s99, v41
    v_cmp_ne_u32_e64 s[22:23], s99, v42
    v_cmp_ne_u32_e64 s[24:25], s99, v43
    v_cmp_ne_u32_e64 s[26:27], s99, v44
    v_cmp_ne_u32_e64 s[28:29], s99, v45
    v_cmp_ne_u32_e64 s[30:31], s99, v46
    s_branch L_tsk14
L_tch13:
    s_branch L_tch9
L_tsk14:
    v_cmp_ne_u32_e64 s[32:33], s99, v47
    v_cmp_ne_u32_e64 s[52:53], 0, v48
    s_cmp_lg_u64 s[18:19], 0
    s_cselect_b64 exec, -1, 0
    global_load_dwordx4 v[4:7], v1, s[6:7] offset:0 sc1
    s_cmp_lg_u64 s[20:21], 0
    s_cselect_b64 exec, -1, 0
    global_load_dwordx4 v[8:11], v1, s[6:7] offset:1024 sc1
    s_cmp_lg_u64 s[22:23], 0
    s_cselect_b64 exec, -1, 0
    global_load_dwordx4 v[12:15], v1, s[6:7] offset:2048 sc1
    s_cmp_lg_u64 s[24:25], 0
    s_cselect_b64 exec, -1, 0
    global_load_dwordx4 v[16:19], v1, s[6:7] offset:3072 sc1
    s_cmp_lg_u64 s[26:27], 0
    s_cselect_b64 exec, -1, 0
    global_load_dwordx4 v[20:23], v56, s[6:7] offset:0 sc1
    s_cmp_lg_u64 s[28:29], 0
    s_cselect_b64 exec, -1, 0
    global_load_dwordx4 v[24:27], v56, s[6:7] offset:1024 sc1
    s_cmp_lg_u64 s[30:31], 0
    s_cselect_b64 exec, -1, 0
    global_load_dwordx4 v[28:31], v56, s[6:7] offset:2048 sc1
    s_cmp_lg_u64 s[32:33], 0
    s_cselect_b64 exec, -1, 0
    global_load_dwordx4 v[32:35], v56, s[6:7] offset:3072 sc1
    s_cmp_lg_u64 s[52:53], 0
    s_cselect_b64 exec, -1, 0
    global_load_dwordx4 v[36:39], v57, s[8:9] sc1
    s_mov_b64 exec, -1
    s_add_u32 s78, s78, 1
    s_cmp_lt_u32 s78, 8192
    s_cbranch_scc1 L_pchk0_O
L_pfail_O:
    s_waitcnt vmcnt(0)
L_pollok_O:
    v_and_b32 v49, 0xffffff00, v36
    s_nop 1
    v_max_f32_dpp v50, v49, v49 quad_perm:[1,0,3,2] row_mask:0xf bank_mask:0xf
    s_nop 1
    v_max_f32_dpp v50, v50, v50 quad_perm:[2,3,0,1] row_mask:0xf bank_mask:0xf
    s_nop 1
    v_max_f32_dpp v50, v50, v50 row_half_mirror row_mask:0xf bank_mask:0xf
    v_mul_f32 v50, s68, v50
    v_fma_f32 v51, v49, s68, -v50
    v_exp_f32 v51, v51
    s_nop 0
    v_mul_f32 v50, v51, v37
    v_mul_f32_dpp v40, v51, v4 row_newbcast:0 row_mask:0xf bank_mask:0xf
    v_mul_f32_dpp v41, v51, v5 row_newbcast:0 row_mask:0xf bank_mask:0xf
    v_mul_f32_dpp v42, v51, v6 row_newbcast:0 row_mask:0xf bank_mask:0xf
    v_mul_f32_dpp v43, v51, v7 row_newbcast:0 row_mask:0xf bank_mask:0xf
    v_add_f32_dpp v50, v50, v50 quad_perm:[1,0,3,2] row_mask:0xf bank_mask:0xf
    v_fmac_f32_dpp v40, v51, v8 row_newbcast:1 row_mask:0xf bank_mask:0xf
    v_fmac_f32_dpp v41, v51, v9 row_newbcast:1 row_mask:0xf bank_mask:0xf
    v_fmac_f32_dpp v42, v51, v10 row_newbcast:1 row_mask:0xf bank_mask:0xf
    v_fmac_f32_dpp v43, v51, v11 row_newbcast:1 row_mask:0xf bank_mask:0xf
    v_add_f32_dpp v50, v50, v50 quad_perm:[2,3,0,1] row_mask:0xf bank_mask:0xf
    v_fmac_f32_dpp v40, v51, v12 row_newbcast:2 row_mask:0xf bank_mask:0xf
    v_fmac_f32_dpp v41, v51, v13 row_newbcast:2 row_mask:0xf bank_mask:0xf
    v_fmac_f32_dpp v42, v51, v14 row_newbcast:2 row_mask:0xf bank_mask:0xf
    v_fmac_f32_dpp v43, v51, v15 row_newbcast:2 row_mask:0xf bank_mask:0xf
    v_add_f32_dpp v50, v50, v50 row_half_mirror row_mask:0xf bank_mask:0xf
    v_fmac_f32_dpp v40, v51, v16 row_newbcast:3 row_mask:0xf bank_mask:0xf
    v_fmac_f32_dpp v41, v51, v17 row_newbcast:3 row_mask:0xf bank_mask:0xf
    v_fmac_f32_dpp v42, v51, v18 row_newbcast:3 row_mask:0xf bank_mask:0xf
    v_fmac_f32_dpp v43, v51, v19 row_newbcast:3 row_mask:0xf bank_mask:0xf
    v_rcp_f32 v50, v50
    v_fmac_f32_dpp v40, v51, v20 row_newbcast:4 row_mask:0xf bank_mask:0xf
    v_fmac_f32_dpp v41, v51, v21 row_newbcast:4 row_mask:0xf bank_mask:0xf
    v_fmac_f32_dpp v42, v51, v22 row_newbcast:4 row_mask:0xf bank_mask:0xf
    v_fmac_f32_dpp v43, v51, v23 row_newbcast:4 row_mask:0xf bank_mask:0xf
    v_fmac_f32_dpp v40, v51, v24 row_newbcast:5 row_mask:0xf bank_mask:0xf
    v_fmac_f32_dpp v41, v51, v25 row_newbcast:5 row_mask:0xf bank_mask:0xf
    v_fmac_f32_dpp v42, v51, v26 row_newbcast:5 row_mask:0xf bank_mask:0xf
    v_fmac_f32_dpp v43, v51, v27 row_newbcast:5 row_mask:0xf bank_mask:0xf
    v_fmac_f32_dpp v40, v51, v28 row_newbcast:6 row_mask:0xf bank_mask:0xf
    v_fmac_f32_dpp v41, v51, v29 row_newbcast:6 row_mask:0xf bank_mask:0xf
    v_fmac_f32_dpp v42, v51, v30 row_newbcast:6 row_mask:0xf bank_mask:0xf
    v_fmac_f32_dpp v43, v51, v31 row_newbcast:6 row_mask:0xf bank_mask:0xf
    v_fmac_f32_dpp v40, v51, v32 row_newbcast:7 row_mask:0xf bank_mask:0xf
    v_fmac_f32_dpp v41, v51, v33 row_newbcast:7 row_mask:0xf bank_mask:0xf
    v_fmac_f32_dpp v42, v51, v34 row_newbcast:7 row_mask:0xf bank_mask:0xf
    v_fmac_f32_dpp v43, v51, v35 row_newbcast:7 row_mask:0xf bank_mask:0xf
    v_mul_f32 v40, v40, v50
    v_mul_f32 v41, v41, v50
    v_mul_f32 v42, v42, v50
    v_mul_f32 v43, v43, v50
    v_cvt_pk_bf16_f32 v52, v40, v41
    v_cvt_pk_bf16_f32 v53, v42, v43
    ds_write_b64 v59, v[52:53] offset:21504
    ds_read_b128 v[44:47], v55 offset:21504
    ds_read_b128 v[48:51], v55 offset:21632
    s_waitcnt lgkmcnt(1)
    v_mfma_f32_16x16x32_bf16 v[64:67], v[44:47], v[64:67], 0
    v_mfma_f32_16x16x32_bf16 v[68:71], v[44:47], v[68:71], 0
    v_mfma_f32_16x16x32_bf16 v[72:75], v[44:47], v[72:75], 0
    v_mfma_f32_16x16x32_bf16 v[76:79], v[44:47], v[76:79], 0
    v_mfma_f32_16x16x32_bf16 v[80:83], v[44:47], v[80:83], 0
    v_mfma_f32_16x16x32_bf16 v[84:87], v[44:47], v[84:87], 0
    v_mfma_f32_16x16x32_bf16 v[88:91], v[44:47], v[88:91], 0
    v_mfma_f32_16x16x32_bf16 v[92:95], v[44:47], v[92:95], 0
    s_waitcnt lgkmcnt(0)
    v_mfma_f32_16x16x32_bf16 v[64:67], v[48:51], v[96:99], v[64:67]
    v_mfma_f32_16x16x32_bf16 v[68:71], v[48:51], v[100:103], v[68:71]
    v_mfma_f32_16x16x32_bf16 v[72:75], v[48:51], v[104:107], v[72:75]
    v_mfma_f32_16x16x32_bf16 v[76:79], v[48:51], v[108:111], v[76:79]
    v_mfma_f32_16x16x32_bf16 v[80:83], v[48:51], v[112:115], v[80:83]
    v_mfma_f32_16x16x32_bf16 v[84:87], v[48:51], v[116:119], v[84:87]
    v_mfma_f32_16x16x32_bf16 v[88:91], v[48:51], v[120:123], v[88:91]
    v_mfma_f32_16x16x32_bf16 v[92:95], v[48:51], v[124:127], v[92:95]
    s_mov_b32 s76, 0x00ff00ff
    s_mov_b32 s77, 0
    v_add_f32_dpp v40, v65, v64 row_ror:8 row_mask:0xf bank_mask:0xf
    v_add_f32_dpp v41, v69, v68 row_ror:8 row_mask:0xf bank_mask:0xf
    v_add_f32_dpp v42, v73, v72 row_ror:8 row_mask:0xf bank_mask:0xf
    v_add_f32_dpp v43, v77, v76 row_ror:8 row_mask:0xf bank_mask:0xf
    v_add_f32_dpp v44, v81, v80 row_ror:8 row_mask:0xf bank_mask:0xf
    v_add_f32_dpp v45, v85, v84 row_ror:8 row_mask:0xf bank_mask:0xf
    v_add_f32_dpp v46, v89, v88 row_ror:8 row_mask:0xf bank_mask:0xf
    v_add_f32_dpp v47, v93, v92 row_ror:8 row_mask:0xf bank_mask:0xf
    s_mov_b64 exec, s[76:77]
    ds_write_b128 v60, v[40:43] offset:13312
    ds_write_b128 v60, v[44:47] offset:13328
    s_mov_b64 exec, -1
    s_waitcnt lgkmcnt(0)
    s_barrier
    s_cmp_lg_u32 s3, 4
    s_cbranch_scc1 L_o_done
    ds_read_b128 v[96:99], v1 offset:13312
    ds_read_b128 v[100:103], v1 offset:14336
    ds_read_b128 v[104:107], v1 offset:15360
    ds_read_b128 v[108:111], v1 offset:16384
    s_waitcnt lgkmcnt(2)
    v_add_f32 v96, v96, v100
    v_add_f32 v97, v97, v101
    v_add_f32 v98, v98, v102
    v_add_f32 v99, v99, v103
    s_waitcnt lgkmcnt(0)
    v_add_f32 v104, v104, v108
    v_add_f32 v105, v105, v109
    v_add_f32 v106, v106, v110
    v_add_f32 v107, v107, v111
    v_add_f32 v96, v96, v104
    v_add_f32 v97, v97, v105
    v_add_f32 v98, v98, v106
    v_add_f32 v99, v99, v107
    v_mov_b32 v100, v96
    v_mov_b32 v101, v97
    v_mov_b32 v102, v98
    v_mov_b32 v103, v99
    v_permlane32_swap_b32 v96, v100
    v_permlane32_swap_b32 v97, v101
    v_permlane32_swap_b32 v98, v102
    v_permlane32_swap_b32 v99, v103
    v_add_f32 v96, v96, v100
    v_add_f32 v97, v97, v101
    v_add_f32 v98, v98, v102
    v_add_f32 v99, v99, v103
    v_perm_b32 v96, v96, v58, s62
    v_perm_b32 v99, v99, v58, s63
    s_mov_b32 exec_hi, 0
    s_cmp_eq_u32 s15, 0
    s_cbranch_scc1 L_far_Y
    global_store_dwordx4 v2, v[96:99], s[72:73] offset:0
    s_branch L_pubd_Y
L_tch14:
    s_branch L_touch_ret
L_far_Y:
    global_store_dwordx4 v2, v[96:99], s[72:73] offset:0 sc1
L_pubd_Y:
    s_mov_b64 exec, -1
L_o_done:
    s_cmp_ge_u32 s79, 22
    s_cbranch_scc1 L_fin
    s_cmp_ge_u32 s3, 4
    s_cbranch_scc1 L_f1_help
    s_mov_b32 s78, 0
    global_load_dwordx4 v[160:163], v134, s[72:73] offset:-4096 sc1
    global_load_dwordx4 v[164:167], v134, s[72:73] offset:0 sc1
    global_load_dwordx4 v[168:171], v135, s[72:73] offset:-4096 sc1
    global_load_dwordx4 v[172:175], v135, s[72:73] offset:0 sc1
L_pchk0_F:
    s_waitcnt vmcnt(0)
    v_perm_b32 v40, v163, v160, s66
    v_perm_b32 v41, v167, v164, s66
    v_perm_b32 v42, v171, v168, s66
    v_perm_b32 v43, v175, v172, s66
    v_xor_b32 v48, s99, v40
    v_bitop3_b32 v48, v48, v41, s99 bitop3:0xf6
    v_bitop3_b32 v48, v48, v42, s99 bitop3:0xf6
    v_bitop3_b32 v48, v48, v43, s99 bitop3:0xf6
    v_cmp_ne_u32 vcc, 0, v48
    s_cbranch_vccz L_pollok_F
    v_cmp_ne_u32_e64 s[18:19], s99, v40
    v_cmp_ne_u32_e64 s[20:21], s99, v41
    v_cmp_ne_u32_e64 s[22:23], s99, v42
    v_cmp_ne_u32_e64 s[24:25], s99, v43
    s_cmp_lg_u64 s[18:19], 0
    s_cselect_b64 exec, -1, 0
    global_load_dwordx4 v[160:163], v134, s[72:73] offset:-4096 sc1
    s_cmp_lg_u64 s[20:21], 0
    s_cselect_b64 exec, -1, 0
    global_load_dwordx4 v[164:167], v134, s[72:73] offset:0 sc1
    s_cmp_lg_u64 s[22:23], 0
    s_cselect_b64 exec, -1, 0
    global_load_dwordx4 v[168:171], v135, s[72:73] offset:-4096 sc1
    s_cmp_lg_u64 s[24:25], 0
    s_cselect_b64 exec, -1, 0
    global_load_dwordx4 v[172:175], v135, s[72:73] offset:0 sc1
    s_mov_b64 exec, -1
    s_add_u32 s78, s78, 1
    s_cmp_lt_u32 s78, 8192
    s_cbranch_scc1 L_pchk0_F
L_pfail_F:
    s_waitcnt vmcnt(0)
L_pollok_F:
    v_add_f32 v4, v160, v164
    v_add_f32 v12, v168, v172
    v_add_f32 v5, v161, v165
    v_add_f32 v13, v169, v173
    v_add_f32 v6, v162, v166
    v_add_f32 v14, v170, v174
    v_add_f32 v7, v163, v167
    v_add_f32 v15, v171, v175
    v_add_f32 v4, v4, v12
    v_add_f32 v5, v5, v13
    v_add_f32 v6, v6, v14
    v_add_f32 v7, v7, v15
    v_cvt_pk_bf16_f32 v48, v4, v5
    v_cvt_pk_bf16_f32 v49, v6, v7
    v_lshlrev_b32 v4, 16, v48
    v_and_b32 v5, 0xffff0000, v48
    v_lshlrev_b32 v6, 16, v49
    v_and_b32 v7, 0xffff0000, v49
    v_add_f32 v4, v4, v128
    v_add_f32 v5, v5, v129
    v_add_f32 v6, v6, v130
    v_add_f32 v7, v7, v131
    v_cvt_pk_bf16_f32 v48, v4, v5
    v_cvt_pk_bf16_f32 v49, v6, v7
    ds_write_b64 v136, v[48:49] offset:9216
    s_waitcnt lgkmcnt(0)
    s_barrier
    ds_read_b128 v[36:39], v61 offset:9216
    ds_read_b128 v[40:43], v61 offset:9344
    s_cmp_ge_u32 s3, 2
    s_cbranch_scc1 L_f1_plain
    ds_read_b128 v[52:55], v141 offset:9216
    s_mov_b32 s10, 0x3f803f80
    s_waitcnt lgkmcnt(2)
    v_mfma_f32_16x16x32_bf16 v[4:7], v[36:39], v[192:195], 0
    v_mfma_f32_16x16x32_bf16 v[8:11], v[36:39], v[196:199], 0
    s_waitcnt lgkmcnt(0)
    v_mfma_f32_16x16x32_bf16 v[12:15], v[36:39], v[200:203], 0
    v_dot2_f32_bf16 v154, v52, s10, 0
    v_dot2_f32_bf16 v155, v52, v52, 0
    v_dot2_f32_bf16 v154, v53, s10, v154
    v_mfma_f32_16x16x32_bf16 v[16:19], v[36:39], v[204:207], 0
    v_dot2_f32_bf16 v155, v53, v53, v155
    v_dot2_f32_bf16 v154, v54, s10, v154
    v_dot2_f32_bf16 v155, v54, v54, v155
    v_mfma_f32_16x16x32_bf16 v[20:23], v[36:39], v[208:211], 0
    v_dot2_f32_bf16 v154, v55, s10, v154
    v_dot2_f32_bf16 v155, v55, v55, v155
    v_mfma_f32_16x16x32_bf16 v[24:27], v[36:39], v[212:215], 0
    s_nop 1
    v_permlane32_swap_b32 v154, v155
    v_mfma_f32_16x16x32_bf16 v[28:31], v[36:39], v[216:219], 0
    v_add_f32 v154, v154, v155
    v_mov_b32 v156, v154
    v_mfma_f32_16x16x32_bf16 v[32:35], v[36:39], v[220:223], 0
    s_nop 0
    v_permlane16_swap_b32 v154, v156
    v_add_f32 v154, v154, v156
    v_mfma_f32_16x16x32_bf16 v[4:7], v[40:43], v[224:227], v[4:7]
    s_nop 0
    v_add_f32_dpp v154, v154, v154 row_ror:8 row_mask:0xf bank_mask:0xf
    v_mfma_f32_16x16x32_bf16 v[8:11], v[40:43], v[228:231], v[8:11]
    s_nop 0
    v_add_f32_dpp v154, v154, v154 row_ror:4 row_mask:0xf bank_mask:0xf
    v_mfma_f32_16x16x32_bf16 v[12:15], v[40:43], v[232:235], v[12:15]
    s_nop 0
    v_add_f32_dpp v154, v154, v154 row_ror:2 row_mask:0xf bank_mask:0xf
    v_mfma_f32_16x16x32_bf16 v[16:19], v[40:43], v[236:239], v[16:19]
    s_nop 0
    v_add_f32_dpp v154, v154, v154 row_ror:1 row_mask:0xf bank_mask:0xf
    v_mov_b32 v155, v154
    v_mfma_f32_16x16x32_bf16 v[20:23], v[40:43], v[240:243], v[20:23]
    s_nop 0
    v_permlane32_swap_b32 v154, v155
    v_mul_f32 v152, 0x3b000000, v154
    v_mul_f32 v155, 0x3b000000, v155
    v_mfma_f32_16x16x32_bf16 v[24:27], v[40:43], v[244:247], v[24:27]
    v_fma_f32 v155, -v152, v152, v155
    v_max_f32 v155, 0, v155
    v_cvt_pk_bf16_f32 v155, v155, v155
    v_mfma_f32_16x16x32_bf16 v[28:31], v[40:43], v[248:251], v[28:31]
    v_and_b32 v155, 0xffff0000, v155
    v_add_f32 v155, 0x3727c5ac, v155
    v_cvt_pk_bf16_f32 v155, v155, v155
    v_mfma_f32_16x16x32_bf16 v[32:35], v[40:43], v[252:255], v[32:35]
    v_and_b32 v155, 0xffff0000, v155
    v_sqrt_f32 v155, v155
    v_cvt_pk_bf16_f32 v152, v152, v152
    v_cvt_pk_bf16_f32 v155, v155, v155
    v_and_b32 v152, 0xffff0000, v152
    v_and_b32 v155, 0xffff0000, v155
    v_rcp_f32 v153, v155
    s_mov_b32 s76, 0x00ff00ff
    s_mov_b32 s77, 0
    v_add_f32_dpp v44, v5, v4 row_ror:8 row_mask:0xf bank_mask:0xf
    v_add_f32_dpp v45, v9, v8 row_ror:8 row_mask:0xf bank_mask:0xf
    v_add_f32_dpp v46, v13, v12 row_ror:8 row_mask:0xf bank_mask:0xf
    v_add_f32_dpp v47, v17, v16 row_ror:8 row_mask:0xf bank_mask:0xf
    v_add_f32_dpp v48, v21, v20 row_ror:8 row_mask:0xf bank_mask:0xf
    v_add_f32_dpp v49, v25, v24 row_ror:8 row_mask:0xf bank_mask:0xf
    v_add_f32_dpp v50, v29, v28 row_ror:8 row_mask:0xf bank_mask:0xf
    v_add_f32_dpp v51, v33, v32 row_ror:8 row_mask:0xf bank_mask:0xf
    s_mov_b64 exec, s[76:77]
    ds_write_b128 v60, v[44:47] offset:17408
    ds_write_b128 v60, v[48:51] offset:17424
    ds_write_b64 v142, v[152:153] offset:28672
    s_mov_b64 exec, -1
    s_waitcnt lgkmcnt(0)
    s_barrier
    s_branch L_f1_done
L_tch15:
    s_branch L_touch_ret
L_f1_help:
    v_bfe_u32 v52, v3, 2, 1
    v_lshlrev_b32 v52, 3, v52
    s_waitcnt vmcnt(0)
    s_barrier
    ds_read_b128 v[36:39], v61 offset:9216
    ds_read_b128 v[40:43], v61 offset:9344
L_f1_plain:
    s_waitcnt lgkmcnt(1)
    v_mfma_f32_16x16x32_bf16 v[4:7], v[36:39], v[192:195], 0
    v_mfma_f32_16x16x32_bf16 v[8:11], v[36:39], v[196:199], 0
    v_mfma_f32_16x16x32_bf16 v[12:15], v[36:39], v[200:203], 0
    v_mfma_f32_16x16x32_bf16 v[16:19], v[36:39], v[204:207], 0
    v_mfma_f32_16x16x32_bf16 v[20:23], v[36:39], v[208:211], 0
    v_mfma_f32_16x16x32_bf16 v[24:27], v[36:39], v[212:215], 0
    v_mfma_f32_16x16x32_bf16 v[28:31], v[36:39], v[216:219], 0
    v_mfma_f32_16x16x32_bf16 v[32:35], v[36:39], v[220:223], 0
    s_waitcnt lgkmcnt(0)
    v_mfma_f32_16x16x32_bf16 v[4:7], v[40:43], v[224:227], v[4:7]
    v_mfma_f32_16x16x32_bf16 v[8:11], v[40:43], v[228:231], v[8:11]
    v_mfma_f32_16x16x32_bf16 v[12:15], v[40:43], v[232:235], v[12:15]
    v_mfma_f32_16x16x32_bf16 v[16:19], v[40:43], v[236:239], v[16:19]
    v_mfma_f32_16x16x32_bf16 v[20:23], v[40:43], v[240:243], v[20:23]
    v_mfma_f32_16x16x32_bf16 v[24:27], v[40:43], v[244:247], v[24:27]
    v_mfma_f32_16x16x32_bf16 v[28:31], v[40:43], v[248:251], v[28:31]
    v_mfma_f32_16x16x32_bf16 v[32:35], v[40:43], v[252:255], v[32:35]
    s_mov_b32 s76, 0x00ff00ff
    s_mov_b32 s77, 0
    v_add_f32_dpp v44, v5, v4 row_ror:8 row_mask:0xf bank_mask:0xf
    v_add_f32_dpp v45, v9, v8 row_ror:8 row_mask:0xf bank_mask:0xf
    v_add_f32_dpp v46, v13, v12 row_ror:8 row_mask:0xf bank_mask:0xf
    v_add_f32_dpp v47, v17, v16 row_ror:8 row_mask:0xf bank_mask:0xf
    v_add_f32_dpp v48, v21, v20 row_ror:8 row_mask:0xf bank_mask:0xf
    v_add_f32_dpp v49, v25, v24 row_ror:8 row_mask:0xf bank_mask:0xf
    v_add_f32_dpp v50, v29, v28 row_ror:8 row_mask:0xf bank_mask:0xf
    v_add_f32_dpp v51, v33, v32 row_ror:8 row_mask:0xf bank_mask:0xf
    s_mov_b64 exec, s[76:77]
    ds_write_b128 v60, v[44:47] offset:17408
    ds_write_b128 v60, v[48:51] offset:17424
    s_mov_b64 exec, -1
    s_waitcnt lgkmcnt(0)
    s_barrier
L_f1_done:
    s_cmp_lt_u32 s3, 4
    s_cbranch_scc1 L_zstage
    ds_read_b128 v[4:7], v63 offset:17408
    ds_read_b128 v[8:11], v63 offset:17920
    ds_read_b128 v[12:15], v63 offset:18432
    ds_read_b128 v[16:19], v63 offset:18944
    ds_read_b128 v[20:23], v63 offset:25600
    ds_read_b64 v[24:25], v52 offset:28672
    s_waitcnt lgkmcnt(4)
    v_add_f32 v4, v4, v8
    v_add_f32 v5, v5, v9
    v_add_f32 v6, v6, v10
    v_add_f32 v7, v7, v11
    s_waitcnt lgkmcnt(2)
    v_add_f32 v12, v12, v16
    v_add_f32 v13, v13, v17
    v_add_f32 v14, v14, v18
    v_add_f32 v15, v15, v19
    v_add_f32 v4, v4, v12
    v_add_f32 v5, v5, v13
    v_add_f32 v6, v6, v14
    v_add_f32 v7, v7, v15
    s_waitcnt lgkmcnt(0)
    v_fma_f32 v4, -v24, v20, v4
    v_fma_f32 v5, -v24, v21, v5
    v_fma_f32 v6, -v24, v22, v6
    v_fma_f32 v7, -v24, v23, v7
    v_mul_f32 v4, v4, v25
    v_mul_f32 v5, v5, v25
    v_mul_f32 v6, v6, v25
    v_mul_f32 v7, v7, v25
    v_cvt_pk_bf16_f32 v48, v4, v5
    v_cvt_pk_bf16_f32 v49, v6, v7
    v_lshlrev_b32 v4, 16, v48
    v_and_b32 v5, 0xffff0000, v48
    v_lshlrev_b32 v6, 16, v49
    v_and_b32 v7, 0xffff0000, v49
    v_mov_b32_dpp v8, v4 row_ror:8 row_mask:0xf bank_mask:0xf
    v_mov_b32_dpp v9, v5 row_ror:8 row_mask:0xf bank_mask:0xf
    v_mov_b32_dpp v10, v6 row_ror:8 row_mask:0xf bank_mask:0xf
    v_mov_b32_dpp v11, v7 row_ror:8 row_mask:0xf bank_mask:0xf
    v_max_f32 v4, 0, v4
    v_max_f32 v5, 0, v5
    v_max_f32 v6, 0, v6
    v_max_f32 v7, 0, v7
    v_mul_f32 v4, v4, v8
    v_mul_f32 v5, v5, v9
    v_mul_f32 v6, v6, v10
    v_mul_f32 v7, v7, v11
    v_cvt_pk_bf16_f32 v44, v4, v5
    v_cvt_pk_bf16_f32 v45, v6, v7
    s_nop 0
    v_mov_b32_dpp v36, v44 quad_perm:[0,0,0,0] row_mask:0xf bank_mask:0xf
    v_mov_b32_dpp v37, v45 quad_perm:[0,0,0,0] row_mask:0xf bank_mask:0xf
    v_mov_b32_dpp v38, v44 quad_perm:[1,1,1,1] row_mask:0xf bank_mask:0xf
    v_mov_b32_dpp v39, v45 quad_perm:[1,1,1,1] row_mask:0xf bank_mask:0xf
    v_mov_b32_dpp v40, v44 quad_perm:[2,2,2,2] row_mask:0xf bank_mask:0xf
    v_mov_b32_dpp v41, v45 quad_perm:[2,2,2,2] row_mask:0xf bank_mask:0xf
    v_mov_b32_dpp v42, v44 quad_perm:[3,3,3,3] row_mask:0xf bank_mask:0xf
    v_mov_b32_dpp v43, v45 quad_perm:[3,3,3,3] row_mask:0xf bank_mask:0xf
    v_mfma_f32_16x16x32_bf16 v[4:7], v[36:39], v[128:131], 0
    v_mfma_f32_16x16x32_bf16 v[8:11], v[36:39], v[132:135], 0
    v_mfma_f32_16x16x32_bf16 v[12:15], v[36:39], v[136:139], 0
    v_mfma_f32_16x16x32_bf16 v[16:19], v[36:39], v[140:143], 0
    v_mfma_f32_16x16x32_bf16 v[20:23], v[36:39], v[144:147], 0
    v_mfma_f32_16x16x32_bf16 v[24:27], v[36:39], v[148:151], 0
    v_mfma_f32_16x16x32_bf16 v[28:31], v[36:39], v[152:155], 0
    v_mfma_f32_16x16x32_bf16 v[32:35], v[36:39], v[156:159], 0
    v_mfma_f32_16x16x32_bf16 v[4:7], v[40:43], v[160:163], v[4:7]
    v_mfma_f32_16x16x32_bf16 v[8:11], v[40:43], v[164:167], v[8:11]
    v_mfma_f32_16x16x32_bf16 v[12:15], v[40:43], v[168:171], v[12:15]
    v_mfma_f32_16x16x32_bf16 v[16:19], v[40:43], v[172:175], v[16:19]
    v_mfma_f32_16x16x32_bf16 v[20:23], v[40:43], v[176:179], v[20:23]
    v_mfma_f32_16x16x32_bf16 v[24:27], v[40:43], v[180:183], v[24:27]
    v_mfma_f32_16x16x32_bf16 v[28:31], v[40:43], v[184:187], v[28:31]
    v_mfma_f32_16x16x32_bf16 v[32:35], v[40:43], v[188:191], v[32:35]
    s_nop 0
    v_perm_b32 v44, v4, v58, s62
    v_mov_b32 v45, v8
    v_mov_b32 v46, v12
    v_perm_b32 v47, v16, v58, s63
    v_perm_b32 v48, v20, v58, s62
    v_mov_b32 v49, v24
    v_mov_b32 v50, v28
    v_perm_b32 v51, v32, v58, s63
    s_mov_b32 exec_hi, 0
    s_cmp_eq_u32 s15, 0
    s_cbranch_scc1 L_far_Z
    global_store_dwordx4 v0, v[44:47], s[74:75] offset:0
    global_store_dwordx4 v0, v[48:51], s[74:75] offset:16
    s_branch L_pubd_Z
L_far_Z:
    global_store_dwordx4 v0, v[44:47], s[74:75] offset:0 sc1
    global_store_dwordx4 v0, v[48:51], s[74:75] offset:16 sc1
L_pubd_Z:
    s_mov_b64 exec, -1
    s_branch L_fin
L_tch16:
    s_branch L_touch_ret
L_zstage:
    s_cmp_ge_u32 s3, 2
    s_cbranch_scc1 L_fin
    s_cmp_ge_u32 s79, 16
    s_cbranch_scc1 L_fin
    ds_read_u16 v40, v140 offset:9216
    v_and_b32 v184, 0xff, v58
    v_mov_b32 v185, 0
    v_mov_b32 v186, 0
    v_bfe_u32 v187, v58, 8, 8
    s_mov_b32 s78, 0
    global_load_dwordx4 v[176:179], v137, s[74:75] sc1
    global_load_dwordx4 v[180:183], v138, s[74:75] sc1
    s_mov_b32 exec_hi, 0xffff
    global_load_dwordx4 v[184:187], v139, s[74:75] sc1
    s_mov_b64 exec, -1
L_pchk0_Z:
    s_waitcnt vmcnt(0) lgkmcnt(0)
    v_perm_b32 v48, v179, v176, s66
    v_perm_b32 v49, v183, v180, s66
    v_perm_b32 v50, v187, v184, s66
    v_xor_b32 v51, s99, v48
    v_bitop3_b32 v51, v51, v49, s99 bitop3:0xf6
    v_bitop3_b32 v51, v51, v50, s99 bitop3:0xf6
    v_cmp_ne_u32 vcc, 0, v51
    s_cbranch_vccz L_pollok_Z
    v_cmp_ne_u32_e64 s[18:19], s99, v48
    v_cmp_ne_u32_e64 s[20:21], s99, v49
    v_cmp_ne_u32_e64 s[22:23], s99, v50
    s_cmp_lg_u64 s[18:19], 0
    s_cselect_b64 exec, -1, 0
    global_load_dwordx4 v[176:179], v137, s[74:75] sc1
    s_cmp_lg_u64 s[20:21], 0
    s_cselect_b64 exec, -1, 0
    global_load_dwordx4 v[180:183], v138, s[74:75] sc1
    s_cmp_lg_u64 s[22:23], 0
    s_cselect_b32 exec_lo, -1, 0
    s_cselect_b32 exec_hi, 0xffff, 0
    global_load_dwordx4 v[184:187], v139, s[74:75] sc1
    s_mov_b64 exec, -1
    s_add_u32 s78, s78, 1
    s_cmp_lt_u32 s78, 8192
    s_cbranch_scc1 L_pchk0_Z
L_pfail_Z:
    s_waitcnt vmcnt(0)
L_pollok_Z:
    v_add_f32 v4, v176, v180
    v_add_f32 v5, v177, v181
    v_add_f32 v6, v178, v182
    v_add_f32 v7, v179, v183
    v_lshlrev_b32 v40, 16, v40
    v_add_f32 v4, v4, v184
    v_add_f32 v5, v5, v185
    v_add_f32 v6, v6, v186
    v_add_f32 v7, v7, v187
    v_permlane16_swap_b32 v4, v5
    s_nop 0
    v_permlane16_swap_b32 v6, v7
    v_add_f32 v4, v4, v5
    v_add_f32 v6, v6, v7
    s_nop 1
    v_permlane32_swap_b32 v4, v6
    v_add_f32 v4, v4, v6
    s_nop 1
    v_add_f32_dpp v4, v4, v4 row_ror:8 row_mask:0xf bank_mask:0xf
    v_cvt_pk_bf16_f32 v4, v4, v4
    v_and_b32 v4, 0xffff0000, v4
    v_add_f32 v4, v4, v40
    v_cvt_pk_bf16_f32 v4, v4, v4
    s_mov_b32 exec_lo, 0x00ff00ff
    s_mov_b32 exec_hi, 0x00ff00ff
    global_store_short v140, v4, s[34:35]
    s_mov_b64 exec, -1
    s_or_b32 s4, s79, s3
    s_cmp_lg_u32 s4, 0
    s_cbranch_scc1 L_nobump
    s_add_u32 s4, s96, 1
    v_mov_b32 v48, s4
    s_mov_b64 exec, 1
    global_store_dword v62, v48, s[38:39] offset:0
    s_mov_b64 exec, -1
L_nobump:
L_fin:
L_end:
    s_endpgm
    .fill 64, 4, 0xbf800000
.section .rodata,"a"
.p2align 6
.amdhsa_kernel sequential_preLN__gqa_block_cached__glu_gated_reglu__decode_kernel
  .amdhsa_next_free_vgpr 256
  .amdhsa_next_free_sgpr 102
  .amdhsa_accum_offset 256
  .amdhsa_group_segment_fixed_size 0
  .amdhsa_kernarg_size 96
  .amdhsa_user_sgpr_count 2
  .amdhsa_user_sgpr_kernarg_segment_ptr 1
  .amdhsa_system_sgpr_workgroup_id_x 1
.end_amdhsa_kernel
```
